```python
import torch

def _softmax(x, axis=-1):
    return torch.softmax(x, dim=axis)

def _gelu(x):
    return torch.nn.functional.gelu(x, approximate='tanh')

def _silu(x):
    return torch.nn.functional.silu(x)

def _sigmoid(x):
    return torch.sigmoid(x)

def _layernorm(x, axis=-1, eps=1e-05):
    m = x.mean(dim=axis, keepdim=True)
    v = x.var(dim=axis, keepdim=True, unbiased=False)
    return (x - m) / torch.sqrt(v + eps)

def _scatter_add(tgt, idx, src, axis=0):
    return tgt.clone().index_add_(axis, idx, src)

def _segment_sum(src, seg, n):
    out = torch.zeros((n,) + src.shape[1:], dtype=src.dtype)
    return out.index_add_(0, seg, src)

def _pad(x, pw):
    flat = tuple((v for pair in reversed(pw) for v in pair))
    return torch.nn.functional.pad(x, flat)
kernel_name = 'adaLN_cond__ssm_conv_h3__glu_gated_swiglu__prompt'

def setup_inputs():

    _w = lambda a: (lambda t: t.to(torch.bfloat16) if t.is_floating_point() else t)(torch.as_tensor(a))

    def _A_setup():
        B, S, D = (1, 2048, 1024)
        ks = 4
        return {'q': _w((lambda *s: torch.randn(*s, dtype=torch.bfloat16) * 0.05)(B, S, D)), 'k': _w((lambda *s: torch.randn(*s, dtype=torch.bfloat16) * 0.8)(B, S, D)), 'v': _w((lambda *s: torch.randn(*s, dtype=torch.bfloat16) * 0.8)(B, S, D)), 'shift_k': _w((lambda *s: torch.randn(*s, dtype=torch.bfloat16) * 0.8)(D, ks) * 0.5), 'ssm_k': _w((lambda *s: torch.randn(*s, dtype=torch.bfloat16) * 0.8)(D, S) * (1.0 / S ** 0.5)), 'ssm_D': _w((lambda *s: torch.randn(*s, dtype=torch.bfloat16) * 0.8)(D))}
    _A_in = _A_setup()

    def _B_setup():
        B, S, D, F = (1, 2048, 1024, 3584)
        return {'x': _w((lambda *s: torch.randn(*s, dtype=torch.bfloat16) * 0.05)(B, S, D)), 'w1': _w((lambda *s: torch.randn(*s, dtype=torch.bfloat16) * 0.8)(D, F) * (2.0 / D) ** 0.5), 'w3': _w((lambda *s: torch.randn(*s, dtype=torch.bfloat16) * 0.8)(D, F) * (2.0 / D) ** 0.5), 'w2': _w((lambda *s: torch.randn(*s, dtype=torch.bfloat16) * 0.8)(F, D) * (2.0 / F) ** 0.5)}
    _B_in = _B_setup()
    return {'A_q': _A_in['q'], 'A_k': _A_in['k'], 'A_v': _A_in['v'], 'A_shift_k': _A_in['shift_k'], 'A_ssm_k': _A_in['ssm_k'], 'A_ssm_D': _A_in['ssm_D'], 'B_x': _B_in['x'], 'B_w1': _B_in['w1'], 'B_w3': _B_in['w3'], 'B_w2': _B_in['w2'], 'c': _w((lambda *s: torch.randn(*s, dtype=torch.bfloat16) * 0.2)(1, 1024) * 8.0), 'w_mod': _w((lambda *s: torch.randn(*s, dtype=torch.bfloat16) * 0.2)(1024, 6 * 1024) * 1024 ** (-0.5) * 8.0)}

def reference(A_q, A_k, A_v, A_shift_k, A_ssm_k, A_ssm_D, B_x, B_w1, B_w3, B_w2, c, w_mod):

    def _A_ref(q, k, v, shift_k, ssm_k, ssm_D):
        B, S, D = q.shape
        ks = shift_k.shape[-1]
        k_pad = _pad(k, ((0, 0), (ks - 1, 0), (0, 0)))
        k_shift = torch.zeros_like(k)
        for t in range(ks):
            k_shift = k_shift + k_pad[:, t:t + S, :] * shift_k[:, ks - 1 - t][None, None, :]
        kv = k_shift * v
        L = 2 * S
        kv_pad = _pad(kv, ((0, 0), (0, S), (0, 0)))
        kf_pad = _pad(ssm_k, ((0, 0), (0, S)))
        kv_f = (lambda x, axes=(-2, -1): torch.fft.rfft2(x.float(), dim=axes))(kv_pad[:, None, :, :], axes=(1, 2))
        kf_f = (lambda x, axes=(-2, -1): torch.fft.rfft2(x.float(), dim=axes))(kf_pad[:, None, :], axes=(1, 2))
        kf_f = (lambda x, *d: x.permute(*d))(kf_f, 1, 2, 0)
        y_f = kv_f * kf_f[None, :, :, :]
        y = (lambda x, s, axes=(-2, -1): torch.fft.irfft2(x, s=s, dim=axes).to(torch.bfloat16))(y_f, (1, L), axes=(1, 2))[:, 0, :S, :]
        y = y + kv * ssm_D[None, None, :]
        return q * y

    def _B_ref(x, w1, w3, w2):
        gate = torch.einsum('bsd,df->bsf', x, w1)
        up = torch.einsum('bsd,df->bsf', x, w3)
        h = _silu(gate) * up
        out = torch.einsum('bsf,fd->bsd', h, w2)
        return out
    x = A_q
    mod = (_silu(c) @ w_mod).reshape(c.shape[0], 6, 1, -1)
    sa, ca, ga, sb, cb, gb = (mod[:, 0].clone(), mod[:, 1].clone(), mod[:, 2].clone(), mod[:, 3].clone(), mod[:, 4].clone(), mod[:, 5].clone())
    h = _layernorm(x, axis=-1) * (1 + ca) + sa
    x = x + ga * _A_ref(h, A_k, A_v, A_shift_k, A_ssm_k, A_ssm_D)
    h = _layernorm(x, axis=-1) * (1 + cb) + sb
    x = x + gb * _B_ref(h, B_w1, B_w3, B_w2)
    return x
```

```asm
; @launch kernel=kvt_kernel grid=(256,1,1) block=(320,1,1) lds=17408
; @launch kernel=conv_kernel grid=(256,1,1) block=(512,1,1) lds=93184
; @launch kernel=ln_kernel grid=(256,1,1) block=(576,1,1) lds=36992
; @launch kernel=gemm1_kernel grid=(256,1,1) block=(512,1,1) lds=163840
; @launch kernel=gemm2_kernel grid=(256,1,1) block=(512,1,1) lds=131072
.amdgcn_target "amdgcn-amd-amdhsa--gfx950"
.text
.globl kvt_kernel
.p2align 8
.type kvt_kernel,@function
kvt_kernel:
    s_cmp_ge_u32 s2, 256
    s_cbranch_scc1 Lkv_end
    v_lshrrev_b32 v1, 6, v0
    s_load_dwordx2 s[34:35], s[0:1], 112
    v_readfirstlane_b32 s18, v1
    s_nop 3
    s_cmp_eq_u32 s18, 4
    s_cbranch_scc1 Lkv_pf
    s_load_dwordx4 s[24:27], s[0:1], 8
    s_load_dwordx2 s[28:29], s[0:1], 24
    s_and_b32 s16, s2, 15
    s_lshr_b32 s17, s2, 4
    v_lshrrev_b32 v1, 3, v0
    v_and_b32 v2, 7, v0
    s_lshl_b32 s18, s17, 18
    s_lshl_b32 s19, s16, 7
    s_add_u32 s18, s18, s19
    v_lshlrev_b32 v3, 13, v1
    v_lshl_add_u32 v3, v2, 4, v3
    v_add_u32 v3, s18, v3
    v_subrev_u32 v4, 6144, v3
    v_subrev_u32 v5, 4096, v3
    v_subrev_u32 v6, 2048, v3
    v_lshlrev_b32 v7, 6, v2
    s_lshl_b32 s19, s16, 9
    v_add_u32 v7, s19, v7
    s_waitcnt lgkmcnt(0)
    s_mov_b32 s4, s24
    s_mov_b32 s5, s25
    s_mov_b32 s6, 0x400000
    s_mov_b32 s7, 0x00020000
    s_mov_b32 s8, s26
    s_mov_b32 s9, s27
    s_mov_b32 s10, 0x400000
    s_mov_b32 s11, 0x00020000
    s_mov_b32 s12, s28
    s_mov_b32 s13, s29
    s_mov_b32 s14, 0x2000
    s_mov_b32 s15, 0x00020000
    s_add_u32 s20, s34, 0x3000000
    s_addc_u32 s21, s35, 0
    s_mov_b32 s22, 0x400000
    s_mov_b32 s23, 0x00020000
    buffer_load_dwordx4 v[16:19], v7, s[12:15], 0 offen offset:0
    buffer_load_dwordx4 v[20:23], v7, s[12:15], 0 offen offset:16
    buffer_load_dwordx4 v[24:27], v7, s[12:15], 0 offen offset:32
    buffer_load_dwordx4 v[28:31], v7, s[12:15], 0 offen offset:48
    buffer_load_dwordx4 v[32:35], v4, s[4:7], 0 offen
    buffer_load_dwordx4 v[36:39], v5, s[4:7], 0 offen
    buffer_load_dwordx4 v[40:43], v6, s[4:7], 0 offen
    s_movk_i32 s19, 0
    buffer_load_dwordx4 v[44:47], v3, s[4:7], s19 offen
    buffer_load_dwordx4 v[60:63], v3, s[8:11], s19 offen
    s_movk_i32 s19, 2048
    buffer_load_dwordx4 v[48:51], v3, s[4:7], s19 offen
    buffer_load_dwordx4 v[64:67], v3, s[8:11], s19 offen
    s_movk_i32 s19, 4096
    buffer_load_dwordx4 v[52:55], v3, s[4:7], s19 offen
    buffer_load_dwordx4 v[68:71], v3, s[8:11], s19 offen
    s_movk_i32 s19, 6144
    buffer_load_dwordx4 v[56:59], v3, s[4:7], s19 offen
    buffer_load_dwordx4 v[72:75], v3, s[8:11], s19 offen
    s_waitcnt vmcnt(11)
    v_lshlrev_b32 v80, 16, v16
    v_and_b32 v88, 0xffff0000, v16
    v_lshlrev_b32 v96, 16, v17
    v_and_b32 v104, 0xffff0000, v17
    v_lshlrev_b32 v81, 16, v18
    v_and_b32 v89, 0xffff0000, v18
    v_lshlrev_b32 v97, 16, v19
    v_and_b32 v105, 0xffff0000, v19
    v_lshlrev_b32 v82, 16, v20
    v_and_b32 v90, 0xffff0000, v20
    v_lshlrev_b32 v98, 16, v21
    v_and_b32 v106, 0xffff0000, v21
    v_lshlrev_b32 v83, 16, v22
    v_and_b32 v91, 0xffff0000, v22
    v_lshlrev_b32 v99, 16, v23
    v_and_b32 v107, 0xffff0000, v23
    v_lshlrev_b32 v84, 16, v24
    v_and_b32 v92, 0xffff0000, v24
    v_lshlrev_b32 v100, 16, v25
    v_and_b32 v108, 0xffff0000, v25
    v_lshlrev_b32 v85, 16, v26
    v_and_b32 v93, 0xffff0000, v26
    v_lshlrev_b32 v101, 16, v27
    v_and_b32 v109, 0xffff0000, v27
    v_lshlrev_b32 v86, 16, v28
    v_and_b32 v94, 0xffff0000, v28
    v_lshlrev_b32 v102, 16, v29
    v_and_b32 v110, 0xffff0000, v29
    v_lshlrev_b32 v87, 16, v30
    v_and_b32 v95, 0xffff0000, v30
    v_lshlrev_b32 v103, 16, v31
    v_and_b32 v111, 0xffff0000, v31
    s_waitcnt vmcnt(6)
    v_lshlrev_b32 v112, 16, v32
    v_and_b32 v113, 0xffff0000, v32
    v_lshlrev_b32 v114, 16, v33
    v_and_b32 v115, 0xffff0000, v33
    v_lshlrev_b32 v116, 16, v34
    v_and_b32 v117, 0xffff0000, v34
    v_lshlrev_b32 v118, 16, v35
    v_and_b32 v119, 0xffff0000, v35
    v_lshlrev_b32 v120, 16, v36
    v_and_b32 v121, 0xffff0000, v36
    v_lshlrev_b32 v122, 16, v37
    v_and_b32 v123, 0xffff0000, v37
    v_lshlrev_b32 v124, 16, v38
    v_and_b32 v125, 0xffff0000, v38
    v_lshlrev_b32 v126, 16, v39
    v_and_b32 v127, 0xffff0000, v39
    v_lshlrev_b32 v128, 16, v40
    v_and_b32 v129, 0xffff0000, v40
    v_lshlrev_b32 v130, 16, v41
    v_and_b32 v131, 0xffff0000, v41
    v_lshlrev_b32 v132, 16, v42
    v_and_b32 v133, 0xffff0000, v42
    v_lshlrev_b32 v134, 16, v43
    v_and_b32 v135, 0xffff0000, v43
    v_lshlrev_b32 v136, 16, v44
    v_and_b32 v137, 0xffff0000, v44
    v_lshlrev_b32 v138, 16, v45
    v_and_b32 v139, 0xffff0000, v45
    v_lshlrev_b32 v140, 16, v46
    v_and_b32 v141, 0xffff0000, v46
    v_lshlrev_b32 v142, 16, v47
    v_and_b32 v143, 0xffff0000, v47
    s_waitcnt vmcnt(4)
    v_lshlrev_b32 v144, 16, v48
    v_and_b32 v145, 0xffff0000, v48
    v_lshlrev_b32 v146, 16, v49
    v_and_b32 v147, 0xffff0000, v49
    v_lshlrev_b32 v148, 16, v50
    v_and_b32 v149, 0xffff0000, v50
    v_lshlrev_b32 v150, 16, v51
    v_and_b32 v151, 0xffff0000, v51
    s_waitcnt vmcnt(2)
    v_lshlrev_b32 v152, 16, v52
    v_and_b32 v153, 0xffff0000, v52
    v_lshlrev_b32 v154, 16, v53
    v_and_b32 v155, 0xffff0000, v53
    v_lshlrev_b32 v156, 16, v54
    v_and_b32 v157, 0xffff0000, v54
    v_lshlrev_b32 v158, 16, v55
    v_and_b32 v159, 0xffff0000, v55
    s_waitcnt vmcnt(0)
    v_lshlrev_b32 v160, 16, v56
    v_and_b32 v161, 0xffff0000, v56
    v_lshlrev_b32 v162, 16, v57
    v_and_b32 v163, 0xffff0000, v57
    v_lshlrev_b32 v164, 16, v58
    v_and_b32 v165, 0xffff0000, v58
    v_lshlrev_b32 v166, 16, v59
    v_and_b32 v167, 0xffff0000, v59
    s_barrier
    v_pk_mul_f32 v[16:17], v[104:105], v[112:113]
    v_cvt_pk_bf16_f32 v8, v16, v17
    v_lshlrev_b32 v16, 16, v8
    v_and_b32 v17, 0xffff0000, v8
    v_pk_mul_f32 v[10:11], v[96:97], v[120:121]
    v_cvt_pk_bf16_f32 v8, v10, v11
    v_lshlrev_b32 v10, 16, v8
    v_and_b32 v11, 0xffff0000, v8
    v_pk_add_f32 v[16:17], v[16:17], v[10:11]
    v_cvt_pk_bf16_f32 v8, v16, v17
    v_lshlrev_b32 v16, 16, v8
    v_and_b32 v17, 0xffff0000, v8
    v_pk_mul_f32 v[10:11], v[88:89], v[128:129]
    v_cvt_pk_bf16_f32 v8, v10, v11
    v_lshlrev_b32 v10, 16, v8
    v_and_b32 v11, 0xffff0000, v8
    v_pk_add_f32 v[16:17], v[16:17], v[10:11]
    v_cvt_pk_bf16_f32 v8, v16, v17
    v_lshlrev_b32 v16, 16, v8
    v_and_b32 v17, 0xffff0000, v8
    v_pk_mul_f32 v[10:11], v[80:81], v[136:137]
    v_cvt_pk_bf16_f32 v8, v10, v11
    v_lshlrev_b32 v10, 16, v8
    v_and_b32 v11, 0xffff0000, v8
    v_pk_add_f32 v[16:17], v[16:17], v[10:11]
    v_cvt_pk_bf16_f32 v8, v16, v17
    v_lshlrev_b32 v16, 16, v8
    v_and_b32 v17, 0xffff0000, v8
    v_lshlrev_b32 v10, 16, v60
    v_and_b32 v11, 0xffff0000, v60
    v_pk_mul_f32 v[16:17], v[16:17], v[10:11]
    v_pk_mul_f32 v[18:19], v[106:107], v[114:115]
    v_cvt_pk_bf16_f32 v12, v18, v19
    v_lshlrev_b32 v18, 16, v12
    v_and_b32 v19, 0xffff0000, v12
    v_pk_mul_f32 v[14:15], v[98:99], v[122:123]
    v_cvt_pk_bf16_f32 v12, v14, v15
    v_lshlrev_b32 v14, 16, v12
    v_and_b32 v15, 0xffff0000, v12
    v_pk_add_f32 v[18:19], v[18:19], v[14:15]
    v_cvt_pk_bf16_f32 v12, v18, v19
    v_lshlrev_b32 v18, 16, v12
    v_and_b32 v19, 0xffff0000, v12
    v_pk_mul_f32 v[14:15], v[90:91], v[130:131]
    v_cvt_pk_bf16_f32 v12, v14, v15
    v_lshlrev_b32 v14, 16, v12
    v_and_b32 v15, 0xffff0000, v12
    v_pk_add_f32 v[18:19], v[18:19], v[14:15]
    v_cvt_pk_bf16_f32 v12, v18, v19
    v_lshlrev_b32 v18, 16, v12
    v_and_b32 v19, 0xffff0000, v12
    v_pk_mul_f32 v[14:15], v[82:83], v[138:139]
    v_cvt_pk_bf16_f32 v12, v14, v15
    v_lshlrev_b32 v14, 16, v12
    v_and_b32 v15, 0xffff0000, v12
    v_pk_add_f32 v[18:19], v[18:19], v[14:15]
    v_cvt_pk_bf16_f32 v12, v18, v19
    v_lshlrev_b32 v18, 16, v12
    v_and_b32 v19, 0xffff0000, v12
    v_lshlrev_b32 v14, 16, v61
    v_and_b32 v15, 0xffff0000, v61
    v_pk_mul_f32 v[18:19], v[18:19], v[14:15]
    v_pk_mul_f32 v[20:21], v[108:109], v[116:117]
    v_cvt_pk_bf16_f32 v8, v20, v21
    v_lshlrev_b32 v20, 16, v8
    v_and_b32 v21, 0xffff0000, v8
    v_pk_mul_f32 v[10:11], v[100:101], v[124:125]
    v_cvt_pk_bf16_f32 v8, v10, v11
    v_lshlrev_b32 v10, 16, v8
    v_and_b32 v11, 0xffff0000, v8
    v_pk_add_f32 v[20:21], v[20:21], v[10:11]
    v_cvt_pk_bf16_f32 v8, v20, v21
    v_lshlrev_b32 v20, 16, v8
    v_and_b32 v21, 0xffff0000, v8
    v_pk_mul_f32 v[10:11], v[92:93], v[132:133]
    v_cvt_pk_bf16_f32 v8, v10, v11
    v_lshlrev_b32 v10, 16, v8
    v_and_b32 v11, 0xffff0000, v8
    v_pk_add_f32 v[20:21], v[20:21], v[10:11]
    v_cvt_pk_bf16_f32 v8, v20, v21
    v_lshlrev_b32 v20, 16, v8
    v_and_b32 v21, 0xffff0000, v8
    v_pk_mul_f32 v[10:11], v[84:85], v[140:141]
    v_cvt_pk_bf16_f32 v8, v10, v11
    v_lshlrev_b32 v10, 16, v8
    v_and_b32 v11, 0xffff0000, v8
    v_pk_add_f32 v[20:21], v[20:21], v[10:11]
    v_cvt_pk_bf16_f32 v8, v20, v21
    v_lshlrev_b32 v20, 16, v8
    v_and_b32 v21, 0xffff0000, v8
    v_lshlrev_b32 v10, 16, v62
    v_and_b32 v11, 0xffff0000, v62
    v_pk_mul_f32 v[20:21], v[20:21], v[10:11]
    v_pk_mul_f32 v[22:23], v[110:111], v[118:119]
    v_cvt_pk_bf16_f32 v12, v22, v23
    v_lshlrev_b32 v22, 16, v12
    v_and_b32 v23, 0xffff0000, v12
    v_pk_mul_f32 v[14:15], v[102:103], v[126:127]
    v_cvt_pk_bf16_f32 v12, v14, v15
    v_lshlrev_b32 v14, 16, v12
    v_and_b32 v15, 0xffff0000, v12
    v_pk_add_f32 v[22:23], v[22:23], v[14:15]
    v_cvt_pk_bf16_f32 v12, v22, v23
    v_lshlrev_b32 v22, 16, v12
    v_and_b32 v23, 0xffff0000, v12
    v_pk_mul_f32 v[14:15], v[94:95], v[134:135]
    v_cvt_pk_bf16_f32 v12, v14, v15
    v_lshlrev_b32 v14, 16, v12
    v_and_b32 v15, 0xffff0000, v12
    v_pk_add_f32 v[22:23], v[22:23], v[14:15]
    v_cvt_pk_bf16_f32 v12, v22, v23
    v_lshlrev_b32 v22, 16, v12
    v_and_b32 v23, 0xffff0000, v12
    v_pk_mul_f32 v[14:15], v[86:87], v[142:143]
    v_cvt_pk_bf16_f32 v12, v14, v15
    v_lshlrev_b32 v14, 16, v12
    v_and_b32 v15, 0xffff0000, v12
    v_pk_add_f32 v[22:23], v[22:23], v[14:15]
    v_cvt_pk_bf16_f32 v12, v22, v23
    v_lshlrev_b32 v22, 16, v12
    v_and_b32 v23, 0xffff0000, v12
    v_lshlrev_b32 v14, 16, v63
    v_and_b32 v15, 0xffff0000, v63
    v_pk_mul_f32 v[22:23], v[22:23], v[14:15]
    v_pk_mul_f32 v[24:25], v[104:105], v[120:121]
    v_cvt_pk_bf16_f32 v8, v24, v25
    v_lshlrev_b32 v24, 16, v8
    v_and_b32 v25, 0xffff0000, v8
    v_pk_mul_f32 v[10:11], v[96:97], v[128:129]
    v_cvt_pk_bf16_f32 v8, v10, v11
    v_lshlrev_b32 v10, 16, v8
    v_and_b32 v11, 0xffff0000, v8
    v_pk_add_f32 v[24:25], v[24:25], v[10:11]
    v_cvt_pk_bf16_f32 v8, v24, v25
    v_lshlrev_b32 v24, 16, v8
    v_and_b32 v25, 0xffff0000, v8
    v_pk_mul_f32 v[10:11], v[88:89], v[136:137]
    v_cvt_pk_bf16_f32 v8, v10, v11
    v_lshlrev_b32 v10, 16, v8
    v_and_b32 v11, 0xffff0000, v8
    v_pk_add_f32 v[24:25], v[24:25], v[10:11]
    v_cvt_pk_bf16_f32 v8, v24, v25
    v_lshlrev_b32 v24, 16, v8
    v_and_b32 v25, 0xffff0000, v8
    v_pk_mul_f32 v[10:11], v[80:81], v[144:145]
    v_cvt_pk_bf16_f32 v8, v10, v11
    v_lshlrev_b32 v10, 16, v8
    v_and_b32 v11, 0xffff0000, v8
    v_pk_add_f32 v[24:25], v[24:25], v[10:11]
    v_cvt_pk_bf16_f32 v8, v24, v25
    v_lshlrev_b32 v24, 16, v8
    v_and_b32 v25, 0xffff0000, v8
    v_lshlrev_b32 v10, 16, v64
    v_and_b32 v11, 0xffff0000, v64
    v_pk_mul_f32 v[24:25], v[24:25], v[10:11]
    v_pk_mul_f32 v[26:27], v[106:107], v[122:123]
    v_cvt_pk_bf16_f32 v12, v26, v27
    v_lshlrev_b32 v26, 16, v12
    v_and_b32 v27, 0xffff0000, v12
    v_pk_mul_f32 v[14:15], v[98:99], v[130:131]
    v_cvt_pk_bf16_f32 v12, v14, v15
    v_lshlrev_b32 v14, 16, v12
    v_and_b32 v15, 0xffff0000, v12
    v_pk_add_f32 v[26:27], v[26:27], v[14:15]
    v_cvt_pk_bf16_f32 v12, v26, v27
    v_lshlrev_b32 v26, 16, v12
    v_and_b32 v27, 0xffff0000, v12
    v_pk_mul_f32 v[14:15], v[90:91], v[138:139]
    v_cvt_pk_bf16_f32 v12, v14, v15
    v_lshlrev_b32 v14, 16, v12
    v_and_b32 v15, 0xffff0000, v12
    v_pk_add_f32 v[26:27], v[26:27], v[14:15]
    v_cvt_pk_bf16_f32 v12, v26, v27
    v_lshlrev_b32 v26, 16, v12
    v_and_b32 v27, 0xffff0000, v12
    v_pk_mul_f32 v[14:15], v[82:83], v[146:147]
    v_cvt_pk_bf16_f32 v12, v14, v15
    v_lshlrev_b32 v14, 16, v12
    v_and_b32 v15, 0xffff0000, v12
    v_pk_add_f32 v[26:27], v[26:27], v[14:15]
    v_cvt_pk_bf16_f32 v12, v26, v27
    v_lshlrev_b32 v26, 16, v12
    v_and_b32 v27, 0xffff0000, v12
    v_lshlrev_b32 v14, 16, v65
    v_and_b32 v15, 0xffff0000, v65
    v_pk_mul_f32 v[26:27], v[26:27], v[14:15]
    v_pk_mul_f32 v[28:29], v[108:109], v[124:125]
    v_cvt_pk_bf16_f32 v8, v28, v29
    v_lshlrev_b32 v28, 16, v8
    v_and_b32 v29, 0xffff0000, v8
    v_pk_mul_f32 v[10:11], v[100:101], v[132:133]
    v_cvt_pk_bf16_f32 v8, v10, v11
    v_lshlrev_b32 v10, 16, v8
    v_and_b32 v11, 0xffff0000, v8
    v_pk_add_f32 v[28:29], v[28:29], v[10:11]
    v_cvt_pk_bf16_f32 v8, v28, v29
    v_lshlrev_b32 v28, 16, v8
    v_and_b32 v29, 0xffff0000, v8
    v_pk_mul_f32 v[10:11], v[92:93], v[140:141]
    v_cvt_pk_bf16_f32 v8, v10, v11
    v_lshlrev_b32 v10, 16, v8
    v_and_b32 v11, 0xffff0000, v8
    v_pk_add_f32 v[28:29], v[28:29], v[10:11]
    v_cvt_pk_bf16_f32 v8, v28, v29
    v_lshlrev_b32 v28, 16, v8
    v_and_b32 v29, 0xffff0000, v8
    v_pk_mul_f32 v[10:11], v[84:85], v[148:149]
    v_cvt_pk_bf16_f32 v8, v10, v11
    v_lshlrev_b32 v10, 16, v8
    v_and_b32 v11, 0xffff0000, v8
    v_pk_add_f32 v[28:29], v[28:29], v[10:11]
    v_cvt_pk_bf16_f32 v8, v28, v29
    v_lshlrev_b32 v28, 16, v8
    v_and_b32 v29, 0xffff0000, v8
    v_lshlrev_b32 v10, 16, v66
    v_and_b32 v11, 0xffff0000, v66
    v_pk_mul_f32 v[28:29], v[28:29], v[10:11]
    v_pk_mul_f32 v[30:31], v[110:111], v[126:127]
    v_cvt_pk_bf16_f32 v12, v30, v31
    v_lshlrev_b32 v30, 16, v12
    v_and_b32 v31, 0xffff0000, v12
    v_pk_mul_f32 v[14:15], v[102:103], v[134:135]
    v_cvt_pk_bf16_f32 v12, v14, v15
    v_lshlrev_b32 v14, 16, v12
    v_and_b32 v15, 0xffff0000, v12
    v_pk_add_f32 v[30:31], v[30:31], v[14:15]
    v_cvt_pk_bf16_f32 v12, v30, v31
    v_lshlrev_b32 v30, 16, v12
    v_and_b32 v31, 0xffff0000, v12
    v_pk_mul_f32 v[14:15], v[94:95], v[142:143]
    v_cvt_pk_bf16_f32 v12, v14, v15
    v_lshlrev_b32 v14, 16, v12
    v_and_b32 v15, 0xffff0000, v12
    v_pk_add_f32 v[30:31], v[30:31], v[14:15]
    v_cvt_pk_bf16_f32 v12, v30, v31
    v_lshlrev_b32 v30, 16, v12
    v_and_b32 v31, 0xffff0000, v12
    v_pk_mul_f32 v[14:15], v[86:87], v[150:151]
    v_cvt_pk_bf16_f32 v12, v14, v15
    v_lshlrev_b32 v14, 16, v12
    v_and_b32 v15, 0xffff0000, v12
    v_pk_add_f32 v[30:31], v[30:31], v[14:15]
    v_cvt_pk_bf16_f32 v12, v30, v31
    v_lshlrev_b32 v30, 16, v12
    v_and_b32 v31, 0xffff0000, v12
    v_lshlrev_b32 v14, 16, v67
    v_and_b32 v15, 0xffff0000, v67
    v_pk_mul_f32 v[30:31], v[30:31], v[14:15]
    v_pk_mul_f32 v[32:33], v[104:105], v[128:129]
    v_cvt_pk_bf16_f32 v8, v32, v33
    v_lshlrev_b32 v32, 16, v8
    v_and_b32 v33, 0xffff0000, v8
    v_pk_mul_f32 v[10:11], v[96:97], v[136:137]
    v_cvt_pk_bf16_f32 v8, v10, v11
    v_lshlrev_b32 v10, 16, v8
    v_and_b32 v11, 0xffff0000, v8
    v_pk_add_f32 v[32:33], v[32:33], v[10:11]
    v_cvt_pk_bf16_f32 v8, v32, v33
    v_lshlrev_b32 v32, 16, v8
    v_and_b32 v33, 0xffff0000, v8
    v_pk_mul_f32 v[10:11], v[88:89], v[144:145]
    v_cvt_pk_bf16_f32 v8, v10, v11
    v_lshlrev_b32 v10, 16, v8
    v_and_b32 v11, 0xffff0000, v8
    v_pk_add_f32 v[32:33], v[32:33], v[10:11]
    v_cvt_pk_bf16_f32 v8, v32, v33
    v_lshlrev_b32 v32, 16, v8
    v_and_b32 v33, 0xffff0000, v8
    v_pk_mul_f32 v[10:11], v[80:81], v[152:153]
    v_cvt_pk_bf16_f32 v8, v10, v11
    v_lshlrev_b32 v10, 16, v8
    v_and_b32 v11, 0xffff0000, v8
    v_pk_add_f32 v[32:33], v[32:33], v[10:11]
    v_cvt_pk_bf16_f32 v8, v32, v33
    v_lshlrev_b32 v32, 16, v8
    v_and_b32 v33, 0xffff0000, v8
    v_lshlrev_b32 v10, 16, v68
    v_and_b32 v11, 0xffff0000, v68
    v_pk_mul_f32 v[32:33], v[32:33], v[10:11]
    v_pk_mul_f32 v[34:35], v[106:107], v[130:131]
    v_cvt_pk_bf16_f32 v12, v34, v35
    v_lshlrev_b32 v34, 16, v12
    v_and_b32 v35, 0xffff0000, v12
    v_pk_mul_f32 v[14:15], v[98:99], v[138:139]
    v_cvt_pk_bf16_f32 v12, v14, v15
    v_lshlrev_b32 v14, 16, v12
    v_and_b32 v15, 0xffff0000, v12
    v_pk_add_f32 v[34:35], v[34:35], v[14:15]
    v_cvt_pk_bf16_f32 v12, v34, v35
    v_lshlrev_b32 v34, 16, v12
    v_and_b32 v35, 0xffff0000, v12
    v_pk_mul_f32 v[14:15], v[90:91], v[146:147]
    v_cvt_pk_bf16_f32 v12, v14, v15
    v_lshlrev_b32 v14, 16, v12
    v_and_b32 v15, 0xffff0000, v12
    v_pk_add_f32 v[34:35], v[34:35], v[14:15]
    v_cvt_pk_bf16_f32 v12, v34, v35
    v_lshlrev_b32 v34, 16, v12
    v_and_b32 v35, 0xffff0000, v12
    v_pk_mul_f32 v[14:15], v[82:83], v[154:155]
    v_cvt_pk_bf16_f32 v12, v14, v15
    v_lshlrev_b32 v14, 16, v12
    v_and_b32 v15, 0xffff0000, v12
    v_pk_add_f32 v[34:35], v[34:35], v[14:15]
    v_cvt_pk_bf16_f32 v12, v34, v35
    v_lshlrev_b32 v34, 16, v12
    v_and_b32 v35, 0xffff0000, v12
    v_lshlrev_b32 v14, 16, v69
    v_and_b32 v15, 0xffff0000, v69
    v_pk_mul_f32 v[34:35], v[34:35], v[14:15]
    v_pk_mul_f32 v[36:37], v[108:109], v[132:133]
    v_cvt_pk_bf16_f32 v8, v36, v37
    v_lshlrev_b32 v36, 16, v8
    v_and_b32 v37, 0xffff0000, v8
    v_pk_mul_f32 v[10:11], v[100:101], v[140:141]
    v_cvt_pk_bf16_f32 v8, v10, v11
    v_lshlrev_b32 v10, 16, v8
    v_and_b32 v11, 0xffff0000, v8
    v_pk_add_f32 v[36:37], v[36:37], v[10:11]
    v_cvt_pk_bf16_f32 v8, v36, v37
    v_lshlrev_b32 v36, 16, v8
    v_and_b32 v37, 0xffff0000, v8
    v_pk_mul_f32 v[10:11], v[92:93], v[148:149]
    v_cvt_pk_bf16_f32 v8, v10, v11
    v_lshlrev_b32 v10, 16, v8
    v_and_b32 v11, 0xffff0000, v8
    v_pk_add_f32 v[36:37], v[36:37], v[10:11]
    v_cvt_pk_bf16_f32 v8, v36, v37
    v_lshlrev_b32 v36, 16, v8
    v_and_b32 v37, 0xffff0000, v8
    v_pk_mul_f32 v[10:11], v[84:85], v[156:157]
    v_cvt_pk_bf16_f32 v8, v10, v11
    v_lshlrev_b32 v10, 16, v8
    v_and_b32 v11, 0xffff0000, v8
    v_pk_add_f32 v[36:37], v[36:37], v[10:11]
    v_cvt_pk_bf16_f32 v8, v36, v37
    v_lshlrev_b32 v36, 16, v8
    v_and_b32 v37, 0xffff0000, v8
    v_lshlrev_b32 v10, 16, v70
    v_and_b32 v11, 0xffff0000, v70
    v_pk_mul_f32 v[36:37], v[36:37], v[10:11]
    v_pk_mul_f32 v[38:39], v[110:111], v[134:135]
    v_cvt_pk_bf16_f32 v12, v38, v39
    v_lshlrev_b32 v38, 16, v12
    v_and_b32 v39, 0xffff0000, v12
    v_pk_mul_f32 v[14:15], v[102:103], v[142:143]
    v_cvt_pk_bf16_f32 v12, v14, v15
    v_lshlrev_b32 v14, 16, v12
    v_and_b32 v15, 0xffff0000, v12
    v_pk_add_f32 v[38:39], v[38:39], v[14:15]
    v_cvt_pk_bf16_f32 v12, v38, v39
    v_lshlrev_b32 v38, 16, v12
    v_and_b32 v39, 0xffff0000, v12
    v_pk_mul_f32 v[14:15], v[94:95], v[150:151]
    v_cvt_pk_bf16_f32 v12, v14, v15
    v_lshlrev_b32 v14, 16, v12
    v_and_b32 v15, 0xffff0000, v12
    v_pk_add_f32 v[38:39], v[38:39], v[14:15]
    v_cvt_pk_bf16_f32 v12, v38, v39
    v_lshlrev_b32 v38, 16, v12
    v_and_b32 v39, 0xffff0000, v12
    v_pk_mul_f32 v[14:15], v[86:87], v[158:159]
    v_cvt_pk_bf16_f32 v12, v14, v15
    v_lshlrev_b32 v14, 16, v12
    v_and_b32 v15, 0xffff0000, v12
    v_pk_add_f32 v[38:39], v[38:39], v[14:15]
    v_cvt_pk_bf16_f32 v12, v38, v39
    v_lshlrev_b32 v38, 16, v12
    v_and_b32 v39, 0xffff0000, v12
    v_lshlrev_b32 v14, 16, v71
    v_and_b32 v15, 0xffff0000, v71
    v_pk_mul_f32 v[38:39], v[38:39], v[14:15]
    v_pk_mul_f32 v[40:41], v[104:105], v[136:137]
    v_cvt_pk_bf16_f32 v8, v40, v41
    v_lshlrev_b32 v40, 16, v8
    v_and_b32 v41, 0xffff0000, v8
    v_pk_mul_f32 v[10:11], v[96:97], v[144:145]
    v_cvt_pk_bf16_f32 v8, v10, v11
    v_lshlrev_b32 v10, 16, v8
    v_and_b32 v11, 0xffff0000, v8
    v_pk_add_f32 v[40:41], v[40:41], v[10:11]
    v_cvt_pk_bf16_f32 v8, v40, v41
    v_lshlrev_b32 v40, 16, v8
    v_and_b32 v41, 0xffff0000, v8
    v_pk_mul_f32 v[10:11], v[88:89], v[152:153]
    v_cvt_pk_bf16_f32 v8, v10, v11
    v_lshlrev_b32 v10, 16, v8
    v_and_b32 v11, 0xffff0000, v8
    v_pk_add_f32 v[40:41], v[40:41], v[10:11]
    v_cvt_pk_bf16_f32 v8, v40, v41
    v_lshlrev_b32 v40, 16, v8
    v_and_b32 v41, 0xffff0000, v8
    v_pk_mul_f32 v[10:11], v[80:81], v[160:161]
    v_cvt_pk_bf16_f32 v8, v10, v11
    v_lshlrev_b32 v10, 16, v8
    v_and_b32 v11, 0xffff0000, v8
    v_pk_add_f32 v[40:41], v[40:41], v[10:11]
    v_cvt_pk_bf16_f32 v8, v40, v41
    v_lshlrev_b32 v40, 16, v8
    v_and_b32 v41, 0xffff0000, v8
    v_lshlrev_b32 v10, 16, v72
    v_and_b32 v11, 0xffff0000, v72
    v_pk_mul_f32 v[40:41], v[40:41], v[10:11]
    v_pk_mul_f32 v[42:43], v[106:107], v[138:139]
    v_cvt_pk_bf16_f32 v12, v42, v43
    v_lshlrev_b32 v42, 16, v12
    v_and_b32 v43, 0xffff0000, v12
    v_pk_mul_f32 v[14:15], v[98:99], v[146:147]
    v_cvt_pk_bf16_f32 v12, v14, v15
    v_lshlrev_b32 v14, 16, v12
    v_and_b32 v15, 0xffff0000, v12
    v_pk_add_f32 v[42:43], v[42:43], v[14:15]
    v_cvt_pk_bf16_f32 v12, v42, v43
    v_lshlrev_b32 v42, 16, v12
    v_and_b32 v43, 0xffff0000, v12
    v_pk_mul_f32 v[14:15], v[90:91], v[154:155]
    v_cvt_pk_bf16_f32 v12, v14, v15
    v_lshlrev_b32 v14, 16, v12
    v_and_b32 v15, 0xffff0000, v12
    v_pk_add_f32 v[42:43], v[42:43], v[14:15]
    v_cvt_pk_bf16_f32 v12, v42, v43
    v_lshlrev_b32 v42, 16, v12
    v_and_b32 v43, 0xffff0000, v12
    v_pk_mul_f32 v[14:15], v[82:83], v[162:163]
    v_cvt_pk_bf16_f32 v12, v14, v15
    v_lshlrev_b32 v14, 16, v12
    v_and_b32 v15, 0xffff0000, v12
    v_pk_add_f32 v[42:43], v[42:43], v[14:15]
    v_cvt_pk_bf16_f32 v12, v42, v43
    v_lshlrev_b32 v42, 16, v12
    v_and_b32 v43, 0xffff0000, v12
    v_lshlrev_b32 v14, 16, v73
    v_and_b32 v15, 0xffff0000, v73
    v_pk_mul_f32 v[42:43], v[42:43], v[14:15]
    v_pk_mul_f32 v[44:45], v[108:109], v[140:141]
    v_cvt_pk_bf16_f32 v8, v44, v45
    v_lshlrev_b32 v44, 16, v8
    v_and_b32 v45, 0xffff0000, v8
    v_pk_mul_f32 v[10:11], v[100:101], v[148:149]
    v_cvt_pk_bf16_f32 v8, v10, v11
    v_lshlrev_b32 v10, 16, v8
    v_and_b32 v11, 0xffff0000, v8
    v_pk_add_f32 v[44:45], v[44:45], v[10:11]
    v_cvt_pk_bf16_f32 v8, v44, v45
    v_lshlrev_b32 v44, 16, v8
    v_and_b32 v45, 0xffff0000, v8
    v_pk_mul_f32 v[10:11], v[92:93], v[156:157]
    v_cvt_pk_bf16_f32 v8, v10, v11
    v_lshlrev_b32 v10, 16, v8
    v_and_b32 v11, 0xffff0000, v8
    v_pk_add_f32 v[44:45], v[44:45], v[10:11]
    v_cvt_pk_bf16_f32 v8, v44, v45
    v_lshlrev_b32 v44, 16, v8
    v_and_b32 v45, 0xffff0000, v8
    v_pk_mul_f32 v[10:11], v[84:85], v[164:165]
    v_cvt_pk_bf16_f32 v8, v10, v11
    v_lshlrev_b32 v10, 16, v8
    v_and_b32 v11, 0xffff0000, v8
    v_pk_add_f32 v[44:45], v[44:45], v[10:11]
    v_cvt_pk_bf16_f32 v8, v44, v45
    v_lshlrev_b32 v44, 16, v8
    v_and_b32 v45, 0xffff0000, v8
    v_lshlrev_b32 v10, 16, v74
    v_and_b32 v11, 0xffff0000, v74
    v_pk_mul_f32 v[44:45], v[44:45], v[10:11]
    v_pk_mul_f32 v[46:47], v[110:111], v[142:143]
    v_cvt_pk_bf16_f32 v12, v46, v47
    v_lshlrev_b32 v46, 16, v12
    v_and_b32 v47, 0xffff0000, v12
    v_pk_mul_f32 v[14:15], v[102:103], v[150:151]
    v_cvt_pk_bf16_f32 v12, v14, v15
    v_lshlrev_b32 v14, 16, v12
    v_and_b32 v15, 0xffff0000, v12
    v_pk_add_f32 v[46:47], v[46:47], v[14:15]
    v_cvt_pk_bf16_f32 v12, v46, v47
    v_lshlrev_b32 v46, 16, v12
    v_and_b32 v47, 0xffff0000, v12
    v_pk_mul_f32 v[14:15], v[94:95], v[158:159]
    v_cvt_pk_bf16_f32 v12, v14, v15
    v_lshlrev_b32 v14, 16, v12
    v_and_b32 v15, 0xffff0000, v12
    v_pk_add_f32 v[46:47], v[46:47], v[14:15]
    v_cvt_pk_bf16_f32 v12, v46, v47
    v_lshlrev_b32 v46, 16, v12
    v_and_b32 v47, 0xffff0000, v12
    v_pk_mul_f32 v[14:15], v[86:87], v[166:167]
    v_cvt_pk_bf16_f32 v12, v14, v15
    v_lshlrev_b32 v14, 16, v12
    v_and_b32 v15, 0xffff0000, v12
    v_pk_add_f32 v[46:47], v[46:47], v[14:15]
    v_cvt_pk_bf16_f32 v12, v46, v47
    v_lshlrev_b32 v46, 16, v12
    v_and_b32 v47, 0xffff0000, v12
    v_lshlrev_b32 v14, 16, v75
    v_and_b32 v15, 0xffff0000, v75
    v_pk_mul_f32 v[46:47], v[46:47], v[14:15]
    v_mul_u32_u24 v8, 2176, v2
    v_lshlrev_b32 v9, 3, v1
    v_sub_u32 v8, v8, v9
    v_add_u32 v8, 248, v8
    v_cvt_pk_bf16_f32 v48, v40, v32
    v_cvt_pk_bf16_f32 v49, v24, v16
    ds_write_b64 v8, v[48:49] offset:0
    v_cvt_pk_bf16_f32 v50, v41, v33
    v_cvt_pk_bf16_f32 v51, v25, v17
    ds_write_b64 v8, v[50:51] offset:272
    v_cvt_pk_bf16_f32 v52, v42, v34
    v_cvt_pk_bf16_f32 v53, v26, v18
    ds_write_b64 v8, v[52:53] offset:544
    v_cvt_pk_bf16_f32 v54, v43, v35
    v_cvt_pk_bf16_f32 v55, v27, v19
    ds_write_b64 v8, v[54:55] offset:816
    v_cvt_pk_bf16_f32 v56, v44, v36
    v_cvt_pk_bf16_f32 v57, v28, v20
    ds_write_b64 v8, v[56:57] offset:1088
    v_cvt_pk_bf16_f32 v58, v45, v37
    v_cvt_pk_bf16_f32 v59, v29, v21
    ds_write_b64 v8, v[58:59] offset:1360
    v_cvt_pk_bf16_f32 v60, v46, v38
    v_cvt_pk_bf16_f32 v61, v30, v22
    ds_write_b64 v8, v[60:61] offset:1632
    v_cvt_pk_bf16_f32 v62, v47, v39
    v_cvt_pk_bf16_f32 v63, v31, v23
    ds_write_b64 v8, v[62:63] offset:1904
    s_waitcnt lgkmcnt(0)
    s_barrier
    v_lshrrev_b32 v8, 4, v0
    v_and_b32 v9, 15, v0
    v_mul_u32_u24 v10, 272, v8
    v_lshl_add_u32 v10, v9, 4, v10
    ds_read_b128 v[16:19], v10 offset:0
    ds_read_b128 v[20:23], v10 offset:4352
    ds_read_b128 v[24:27], v10 offset:8704
    ds_read_b128 v[28:31], v10 offset:13056
    v_lshlrev_b32 v11, 12, v8
    v_lshl_add_u32 v11, v9, 4, v11
    s_lshl_b32 s18, s16, 18
    s_lshl_b32 s19, s17, 8
    s_sub_u32 s18, s18, s19
    s_add_u32 s18, s18, 3840
    s_waitcnt lgkmcnt(3)
    s_add_u32 s19, s18, 0
    buffer_store_dwordx4 v[16:19], v11, s[20:23], s19 offen
    s_waitcnt lgkmcnt(2)
    s_add_u32 s19, s18, 65536
    buffer_store_dwordx4 v[20:23], v11, s[20:23], s19 offen
    s_waitcnt lgkmcnt(1)
    s_add_u32 s19, s18, 131072
    buffer_store_dwordx4 v[24:27], v11, s[20:23], s19 offen
    s_waitcnt lgkmcnt(0)
    s_add_u32 s19, s18, 196608
    buffer_store_dwordx4 v[28:31], v11, s[20:23], s19 offen
    s_endpgm
Lkv_pf:
    s_load_dwordx2 s[24:25], s[0:1], 32
    s_load_dwordx4 s[44:47], s[0:1], 56
    v_and_b32 v2, 63, v0
    v_lshlrev_b32 v3, 7, v2
    s_lshl_b32 s19, s2, 14
    v_mul_u32_u24 v10, 9363, v2
    v_lshrrev_b32 v10, 16, v10
    v_mul_u32_u24 v11, 7, v10
    v_sub_u32 v11, v2, v11
    s_movk_i32 s20, 7168
    v_mul_lo_u32 v10, v10, s20
    v_lshl_add_u32 v10, v11, 7, v10
    v_cmp_gt_u32 vcc, 56, v2
    v_mov_b32 v11, 0x80000000
    s_nop 1
    v_cndmask_b32 v10, v11, v10, vcc
    s_and_b32 s43, s2, 7
    s_mul_i32 s43, s43, 896
    s_lshr_b32 s42, s2, 3
    s_mul_i32 s42, s42, 57344
    s_add_u32 s43, s43, s42
    s_add_u32 s43, s43, 3670016
    s_waitcnt lgkmcnt(0)
    s_mov_b32 s4, s24
    s_mov_b32 s5, s25
    s_mov_b32 s6, 0x400000
    s_mov_b32 s7, 0x00020000
    s_mov_b32 s48, s44
    s_mov_b32 s49, s45
    s_mov_b32 s50, 0x700000
    s_mov_b32 s51, 0x00020000
    s_mov_b32 s52, s46
    s_mov_b32 s53, s47
    s_mov_b32 s54, 0x700000
    s_mov_b32 s55, 0x00020000
    s_add_u32 s36, s34, 0x10000
    s_addc_u32 s37, s35, 0
    s_mov_b32 s38, 0x4000
    s_mov_b32 s39, 0x00020000
    s_add_u32 s56, s34, 0x18000
    s_addc_u32 s57, s35, 0
    s_mov_b32 s58, 0x400
    s_mov_b32 s59, 0x00020000
    v_mov_b32 v6, 0
    v_mov_b32 v7, 0
    s_lshl_b32 s21, s2, 7
    s_lshl_b32 s22, s2, 2
    v_cmp_eq_u32 vcc, 0, v2
    s_and_saveexec_b64 s[40:41], vcc
    buffer_store_dword v6, v7, s[36:39], s21 offen
    buffer_store_dword v6, v7, s[56:59], s22 offen
    s_mov_b64 exec, s[40:41]
    s_barrier
    buffer_load_dword v4, v3, s[4:7], s19 offen
    s_add_u32 s19, s19, 8192
    buffer_load_dword v5, v3, s[4:7], s19 offen
    s_barrier
Lkv_end:
    s_endpgm
.text
.globl conv_kernel
.p2align 8
.type conv_kernel,@function
conv_kernel:
    s_cmp_ge_u32 s2, 256
    s_cbranch_scc1 Lcv_end
    s_load_dwordx4 s[28:31], s[0:1], 32
    s_load_dwordx2 s[34:35], s[0:1], 112
    v_lshrrev_b32 v1, 6, v0
    v_and_b32 v2, 63, v0
    v_readfirstlane_b32 s18, v1
    s_nop 3
    s_cmp_ge_u32 s18, 4
    s_cbranch_scc1 Lcv_pf
    s_and_b32 s16, s2, 7
    s_lshl_b32 s16, s16, 5
    s_lshr_b32 s17, s2, 3
    s_add_u32 s16, s16, s17
    s_lshl_b32 s17, s16, 2
    s_add_u32 s17, s17, s18
    v_lshlrev_b32 v3, 4, v2
    v_subrev_u32 v8, 32, v3
    v_subrev_u32 v9, 16, v3
    v_add_u32 v5, 992, v3
    s_waitcnt lgkmcnt(0)
    s_lshl_b32 s19, s16, 3
    s_add_u32 s30, s30, s19
    s_addc_u32 s31, s31, 0
    s_load_dwordx2 s[48:49], s[30:31], 0
    s_lshl_b32 s19, s17, 12
    s_add_u32 s12, s28, s19
    s_addc_u32 s13, s29, 0
    s_movk_i32 s14, 4096
    s_mov_b32 s15, 0x00020000
    s_add_u32 s4, s34, 0x3000000
    s_addc_u32 s5, s35, 0
    s_mov_b32 s6, 0x400000
    s_mov_b32 s7, 0x00020000
    buffer_load_dwordx4 v[104:107], v8, s[12:15], 0 offen
    buffer_load_dwordx2 v[108:109], v9, s[12:15], 0 offen
    buffer_load_dwordx4 v[112:115], v5, s[12:15], 0 offen offset:0
    buffer_load_dwordx2 v[116:117], v5, s[12:15], 0 offen offset:16
    buffer_load_dwordx4 v[120:123], v5, s[12:15], 0 offen offset:1024
    buffer_load_dwordx2 v[124:125], v5, s[12:15], 0 offen offset:1040
    buffer_load_dwordx4 v[128:131], v5, s[12:15], 0 offen offset:2048
    buffer_load_dwordx2 v[132:133], v5, s[12:15], 0 offen offset:2064
    buffer_load_dwordx4 v[136:139], v5, s[12:15], 0 offen offset:3072
    buffer_load_dwordx2 v[140:141], v5, s[12:15], 0 offen offset:3088
    s_mul_i32 s50, s18, 4608
    s_add_u32 m0, s50, 0
    s_add_u32 s40, s19, 0
    buffer_load_dwordx4 v3, s[4:7], s40 offen lds
    s_add_u32 m0, s50, 1024
    s_add_u32 s40, s19, 1024
    buffer_load_dwordx4 v3, s[4:7], s40 offen lds
    s_add_u32 m0, s50, 2048
    s_add_u32 s40, s19, 2048
    buffer_load_dwordx4 v3, s[4:7], s40 offen lds
    s_add_u32 m0, s50, 3072
    s_add_u32 s40, s19, 3072
    buffer_load_dwordx4 v3, s[4:7], s40 offen lds
    s_waitcnt lgkmcnt(0)
    s_cmp_lt_u32 s18, 2
    s_cselect_b32 s51, s48, s49
    s_lshl_b32 s57, s51, 16
    s_and_b32 s51, s51, 0xffff0000
    s_bitcmp1_b32 s18, 0
    s_cselect_b32 s51, s51, s57
    v_mov_b32 v12, 0
    v_mov_b32 v13, 0
    v_mov_b32 v14, 0
    v_mov_b32 v15, 0
    s_mul_i32 s19, s18, 4608
    s_add_u32 s19, s19, 4096
    v_add_u32 v11, s19, v3
    v_cmp_gt_u32 vcc, 32, v2
    s_and_saveexec_b64 s[58:59], vcc
    ds_write_b128 v11, v[12:15]
    s_mov_b64 exec, s[58:59]
    s_mul_i32 s19, s18, 16640
    s_add_u32 s19, s19, 26624
    v_add_u32 v9, s19, v3
    s_waitcnt vmcnt(12)
    ds_write_b128 v9, v[104:107] offset:0
    v_alignbit_b32 v12, v105, v104, 16
    v_alignbit_b32 v13, v106, v105, 16
    v_alignbit_b32 v14, v107, v106, 16
    v_alignbit_b32 v15, v108, v107, 16
    ds_write_b128 v9, v[12:15] offset:4160
    v_mov_b32 v16, v105
    v_mov_b32 v17, v106
    v_mov_b32 v18, v107
    v_mov_b32 v19, v108
    ds_write_b128 v9, v[16:19] offset:8320
    v_alignbit_b32 v20, v106, v105, 16
    v_alignbit_b32 v21, v107, v106, 16
    v_alignbit_b32 v22, v108, v107, 16
    v_alignbit_b32 v23, v109, v108, 16
    ds_write_b128 v9, v[20:23] offset:12480
    s_waitcnt vmcnt(10)
    ds_write_b128 v9, v[112:115] offset:1024
    v_alignbit_b32 v12, v113, v112, 16
    v_alignbit_b32 v13, v114, v113, 16
    v_alignbit_b32 v14, v115, v114, 16
    v_alignbit_b32 v15, v116, v115, 16
    ds_write_b128 v9, v[12:15] offset:5184
    v_mov_b32 v16, v113
    v_mov_b32 v17, v114
    v_mov_b32 v18, v115
    v_mov_b32 v19, v116
    ds_write_b128 v9, v[16:19] offset:9344
    v_alignbit_b32 v20, v114, v113, 16
    v_alignbit_b32 v21, v115, v114, 16
    v_alignbit_b32 v22, v116, v115, 16
    v_alignbit_b32 v23, v117, v116, 16
    ds_write_b128 v9, v[20:23] offset:13504
    s_waitcnt vmcnt(8)
    ds_write_b128 v9, v[120:123] offset:2048
    v_alignbit_b32 v12, v121, v120, 16
    v_alignbit_b32 v13, v122, v121, 16
    v_alignbit_b32 v14, v123, v122, 16
    v_alignbit_b32 v15, v124, v123, 16
    ds_write_b128 v9, v[12:15] offset:6208
    v_mov_b32 v16, v121
    v_mov_b32 v17, v122
    v_mov_b32 v18, v123
    v_mov_b32 v19, v124
    ds_write_b128 v9, v[16:19] offset:10368
    v_alignbit_b32 v20, v122, v121, 16
    v_alignbit_b32 v21, v123, v122, 16
    v_alignbit_b32 v22, v124, v123, 16
    v_alignbit_b32 v23, v125, v124, 16
    ds_write_b128 v9, v[20:23] offset:14528
    s_waitcnt vmcnt(6)
    ds_write_b128 v9, v[128:131] offset:3072
    v_alignbit_b32 v12, v129, v128, 16
    v_alignbit_b32 v13, v130, v129, 16
    v_alignbit_b32 v14, v131, v130, 16
    v_alignbit_b32 v15, v132, v131, 16
    ds_write_b128 v9, v[12:15] offset:7232
    v_mov_b32 v16, v129
    v_mov_b32 v17, v130
    v_mov_b32 v18, v131
    v_mov_b32 v19, v132
    ds_write_b128 v9, v[16:19] offset:11392
    v_alignbit_b32 v20, v130, v129, 16
    v_alignbit_b32 v21, v131, v130, 16
    v_alignbit_b32 v22, v132, v131, 16
    v_alignbit_b32 v23, v133, v132, 16
    ds_write_b128 v9, v[20:23] offset:15552
    s_waitcnt vmcnt(4)
    v_cmp_gt_u32 vcc, 4, v2
    s_and_saveexec_b64 s[58:59], vcc
    ds_write_b128 v9, v[136:139] offset:4096
    v_alignbit_b32 v12, v137, v136, 16
    v_alignbit_b32 v13, v138, v137, 16
    v_alignbit_b32 v14, v139, v138, 16
    v_alignbit_b32 v15, v140, v139, 16
    ds_write_b128 v9, v[12:15] offset:8256
    v_mov_b32 v16, v137
    v_mov_b32 v17, v138
    v_mov_b32 v18, v139
    v_mov_b32 v19, v140
    ds_write_b128 v9, v[16:19] offset:12416
    v_alignbit_b32 v20, v138, v137, 16
    v_alignbit_b32 v21, v139, v138, 16
    v_alignbit_b32 v22, v140, v139, 16
    v_alignbit_b32 v23, v141, v140, 16
    ds_write_b128 v9, v[20:23] offset:16576
    s_mov_b64 exec, s[58:59]
    s_waitcnt vmcnt(0)
    v_and_b32 v10, 15, v2
    v_lshrrev_b32 v11, 4, v2
    v_add_u32 v12, 1, v10
    v_and_b32 v13, 3, v12
    v_lshrrev_b32 v12, 2, v12
    v_mul_u32_u24 v13, 4160, v13
    v_lshl_add_u32 v13, v12, 3, v13
    v_lshl_add_u32 v13, v11, 4, v13
    s_mul_i32 s19, s18, 16640
    s_add_u32 s19, s19, 26624
    v_add_u32 v3, s19, v13
    v_lshlrev_b32 v12, 5, v10
    v_lshlrev_b32 v13, 4, v11
    v_sub_u32 v12, v13, v12
    s_mul_i32 s19, s18, 4608
    s_add_u32 s19, s19, 480
    v_add_u32 v4, s19, v12
    v_mov_b32 v160, 0
    v_mov_b32 v161, 0
    v_mov_b32 v162, 0
    v_mov_b32 v163, 0
    v_mov_b32 v164, 0
    v_mov_b32 v165, 0
    v_mov_b32 v166, 0
    v_mov_b32 v167, 0
    v_mov_b32 v168, 0
    v_mov_b32 v169, 0
    v_mov_b32 v170, 0
    v_mov_b32 v171, 0
    v_mov_b32 v172, 0
    v_mov_b32 v173, 0
    v_mov_b32 v174, 0
    v_mov_b32 v175, 0
    v_mov_b32 v176, 0
    v_mov_b32 v177, 0
    v_mov_b32 v178, 0
    v_mov_b32 v179, 0
    v_mov_b32 v180, 0
    v_mov_b32 v181, 0
    v_mov_b32 v182, 0
    v_mov_b32 v183, 0
    v_mov_b32 v184, 0
    v_mov_b32 v185, 0
    v_mov_b32 v186, 0
    v_mov_b32 v187, 0
    v_mov_b32 v188, 0
    v_mov_b32 v189, 0
    v_mov_b32 v190, 0
    v_mov_b32 v191, 0
    s_waitcnt lgkmcnt(0)
    ds_read_b64 v[32:33], v3 offset:0
    ds_read_b64 v[34:35], v3 offset:8
    ds_read_b128 v[64:67], v4 offset:3584
    ds_read_b64 v[36:37], v3 offset:512
    ds_read_b64 v[38:39], v3 offset:520
    ds_read_b128 v[68:71], v4 offset:3072
    ds_read_b64 v[40:41], v3 offset:1024
    ds_read_b64 v[42:43], v3 offset:1032
    ds_read_b128 v[72:75], v4 offset:2560
    ds_read_b64 v[44:45], v3 offset:1536
    ds_read_b64 v[46:47], v3 offset:1544
    ds_read_b128 v[76:79], v4 offset:2048
    ds_read_b64 v[48:49], v3 offset:2048
    ds_read_b64 v[50:51], v3 offset:2056
    ds_read_b128 v[80:83], v4 offset:1536
    ds_read_b64 v[52:53], v3 offset:2560
    ds_read_b64 v[54:55], v3 offset:2568
    ds_read_b128 v[84:87], v4 offset:1024
    ds_read_b64 v[56:57], v3 offset:3072
    ds_read_b64 v[58:59], v3 offset:3080
    ds_read_b128 v[88:91], v4 offset:512
    ds_read_b64 v[60:61], v3 offset:3584
    ds_read_b64 v[62:63], v3 offset:3592
    ds_read_b128 v[92:95], v4 offset:0
    s_waitcnt lgkmcnt(0)
    v_mfma_f32_16x16x32_bf16 v[160:163], v[32:35], v[64:67], v[160:163]
    ds_read_b64 v[96:97], v3 offset:64
    v_mfma_f32_16x16x32_bf16 v[164:167], v[32:35], v[68:71], v[164:167]
    ds_read_b64 v[98:99], v3 offset:72
    v_mfma_f32_16x16x32_bf16 v[164:167], v[36:39], v[64:67], v[164:167]
    ds_read_b128 v[128:131], v4 offset:3648
    v_mfma_f32_16x16x32_bf16 v[168:171], v[32:35], v[72:75], v[168:171]
    ds_read_b64 v[100:101], v3 offset:576
    v_mfma_f32_16x16x32_bf16 v[168:171], v[36:39], v[68:71], v[168:171]
    ds_read_b64 v[102:103], v3 offset:584
    v_mfma_f32_16x16x32_bf16 v[168:171], v[40:43], v[64:67], v[168:171]
    ds_read_b128 v[132:135], v4 offset:3136
    v_mfma_f32_16x16x32_bf16 v[172:175], v[32:35], v[76:79], v[172:175]
    ds_read_b64 v[104:105], v3 offset:1088
    v_mfma_f32_16x16x32_bf16 v[172:175], v[36:39], v[72:75], v[172:175]
    ds_read_b64 v[106:107], v3 offset:1096
    v_mfma_f32_16x16x32_bf16 v[172:175], v[40:43], v[68:71], v[172:175]
    ds_read_b128 v[136:139], v4 offset:2624
    v_mfma_f32_16x16x32_bf16 v[172:175], v[44:47], v[64:67], v[172:175]
    ds_read_b64 v[108:109], v3 offset:1600
    v_mfma_f32_16x16x32_bf16 v[176:179], v[32:35], v[80:83], v[176:179]
    ds_read_b64 v[110:111], v3 offset:1608
    v_mfma_f32_16x16x32_bf16 v[176:179], v[36:39], v[76:79], v[176:179]
    ds_read_b128 v[140:143], v4 offset:2112
    v_mfma_f32_16x16x32_bf16 v[176:179], v[40:43], v[72:75], v[176:179]
    ds_read_b64 v[112:113], v3 offset:2112
    v_mfma_f32_16x16x32_bf16 v[176:179], v[44:47], v[68:71], v[176:179]
    ds_read_b64 v[114:115], v3 offset:2120
    v_mfma_f32_16x16x32_bf16 v[176:179], v[48:51], v[64:67], v[176:179]
    ds_read_b128 v[144:147], v4 offset:1600
    v_mfma_f32_16x16x32_bf16 v[180:183], v[32:35], v[84:87], v[180:183]
    ds_read_b64 v[116:117], v3 offset:2624
    v_mfma_f32_16x16x32_bf16 v[180:183], v[36:39], v[80:83], v[180:183]
    ds_read_b64 v[118:119], v3 offset:2632
    v_mfma_f32_16x16x32_bf16 v[180:183], v[40:43], v[76:79], v[180:183]
    ds_read_b128 v[148:151], v4 offset:1088
    v_mfma_f32_16x16x32_bf16 v[180:183], v[44:47], v[72:75], v[180:183]
    ds_read_b64 v[120:121], v3 offset:3136
    v_mfma_f32_16x16x32_bf16 v[180:183], v[48:51], v[68:71], v[180:183]
    ds_read_b64 v[122:123], v3 offset:3144
    v_mfma_f32_16x16x32_bf16 v[180:183], v[52:55], v[64:67], v[180:183]
    ds_read_b128 v[152:155], v4 offset:576
    v_mfma_f32_16x16x32_bf16 v[184:187], v[32:35], v[88:91], v[184:187]
    ds_read_b64 v[124:125], v3 offset:3648
    v_mfma_f32_16x16x32_bf16 v[184:187], v[36:39], v[84:87], v[184:187]
    ds_read_b64 v[126:127], v3 offset:3656
    v_mfma_f32_16x16x32_bf16 v[184:187], v[40:43], v[80:83], v[184:187]
    ds_read_b128 v[156:159], v4 offset:64
    v_mfma_f32_16x16x32_bf16 v[184:187], v[44:47], v[76:79], v[184:187]
    v_mfma_f32_16x16x32_bf16 v[184:187], v[48:51], v[72:75], v[184:187]
    v_mfma_f32_16x16x32_bf16 v[184:187], v[52:55], v[68:71], v[184:187]
    v_mfma_f32_16x16x32_bf16 v[184:187], v[56:59], v[64:67], v[184:187]
    v_mfma_f32_16x16x32_bf16 v[188:191], v[32:35], v[92:95], v[188:191]
    v_mfma_f32_16x16x32_bf16 v[188:191], v[36:39], v[88:91], v[188:191]
    v_mfma_f32_16x16x32_bf16 v[188:191], v[40:43], v[84:87], v[188:191]
    v_mfma_f32_16x16x32_bf16 v[188:191], v[44:47], v[80:83], v[188:191]
    v_mfma_f32_16x16x32_bf16 v[188:191], v[48:51], v[76:79], v[188:191]
    v_mfma_f32_16x16x32_bf16 v[188:191], v[52:55], v[72:75], v[188:191]
    v_mfma_f32_16x16x32_bf16 v[188:191], v[56:59], v[68:71], v[188:191]
    v_mfma_f32_16x16x32_bf16 v[188:191], v[60:63], v[64:67], v[188:191]
    s_waitcnt lgkmcnt(0)
    v_mfma_f32_16x16x32_bf16 v[160:163], v[96:99], v[128:131], v[160:163]
    ds_read_b64 v[32:33], v3 offset:128
    v_mfma_f32_16x16x32_bf16 v[164:167], v[96:99], v[132:135], v[164:167]
    ds_read_b64 v[34:35], v3 offset:136
    v_mfma_f32_16x16x32_bf16 v[164:167], v[100:103], v[128:131], v[164:167]
    ds_read_b128 v[64:67], v4 offset:3712
    v_mfma_f32_16x16x32_bf16 v[168:171], v[96:99], v[136:139], v[168:171]
    ds_read_b64 v[36:37], v3 offset:640
    v_mfma_f32_16x16x32_bf16 v[168:171], v[100:103], v[132:135], v[168:171]
    ds_read_b64 v[38:39], v3 offset:648
    v_mfma_f32_16x16x32_bf16 v[168:171], v[104:107], v[128:131], v[168:171]
    ds_read_b128 v[68:71], v4 offset:3200
    v_mfma_f32_16x16x32_bf16 v[172:175], v[96:99], v[140:143], v[172:175]
    ds_read_b64 v[40:41], v3 offset:1152
    v_mfma_f32_16x16x32_bf16 v[172:175], v[100:103], v[136:139], v[172:175]
    ds_read_b64 v[42:43], v3 offset:1160
    v_mfma_f32_16x16x32_bf16 v[172:175], v[104:107], v[132:135], v[172:175]
    ds_read_b128 v[72:75], v4 offset:2688
    v_mfma_f32_16x16x32_bf16 v[172:175], v[108:111], v[128:131], v[172:175]
    ds_read_b64 v[44:45], v3 offset:1664
    v_mfma_f32_16x16x32_bf16 v[176:179], v[96:99], v[144:147], v[176:179]
    ds_read_b64 v[46:47], v3 offset:1672
    v_mfma_f32_16x16x32_bf16 v[176:179], v[100:103], v[140:143], v[176:179]
    ds_read_b128 v[76:79], v4 offset:2176
    v_mfma_f32_16x16x32_bf16 v[176:179], v[104:107], v[136:139], v[176:179]
    ds_read_b64 v[48:49], v3 offset:2176
    v_mfma_f32_16x16x32_bf16 v[176:179], v[108:111], v[132:135], v[176:179]
    ds_read_b64 v[50:51], v3 offset:2184
    v_mfma_f32_16x16x32_bf16 v[176:179], v[112:115], v[128:131], v[176:179]
    ds_read_b128 v[80:83], v4 offset:1664
    v_mfma_f32_16x16x32_bf16 v[180:183], v[96:99], v[148:151], v[180:183]
    ds_read_b64 v[52:53], v3 offset:2688
    v_mfma_f32_16x16x32_bf16 v[180:183], v[100:103], v[144:147], v[180:183]
    ds_read_b64 v[54:55], v3 offset:2696
    v_mfma_f32_16x16x32_bf16 v[180:183], v[104:107], v[140:143], v[180:183]
    ds_read_b128 v[84:87], v4 offset:1152
    v_mfma_f32_16x16x32_bf16 v[180:183], v[108:111], v[136:139], v[180:183]
    ds_read_b64 v[56:57], v3 offset:3200
    v_mfma_f32_16x16x32_bf16 v[180:183], v[112:115], v[132:135], v[180:183]
    ds_read_b64 v[58:59], v3 offset:3208
    v_mfma_f32_16x16x32_bf16 v[180:183], v[116:119], v[128:131], v[180:183]
    ds_read_b128 v[88:91], v4 offset:640
    v_mfma_f32_16x16x32_bf16 v[184:187], v[96:99], v[152:155], v[184:187]
    ds_read_b64 v[60:61], v3 offset:3712
    v_mfma_f32_16x16x32_bf16 v[184:187], v[100:103], v[148:151], v[184:187]
    ds_read_b64 v[62:63], v3 offset:3720
    v_mfma_f32_16x16x32_bf16 v[184:187], v[104:107], v[144:147], v[184:187]
    ds_read_b128 v[92:95], v4 offset:128
    v_mfma_f32_16x16x32_bf16 v[184:187], v[108:111], v[140:143], v[184:187]
    v_mfma_f32_16x16x32_bf16 v[184:187], v[112:115], v[136:139], v[184:187]
    v_mfma_f32_16x16x32_bf16 v[184:187], v[116:119], v[132:135], v[184:187]
    v_mfma_f32_16x16x32_bf16 v[184:187], v[120:123], v[128:131], v[184:187]
    v_mfma_f32_16x16x32_bf16 v[188:191], v[96:99], v[156:159], v[188:191]
    v_mfma_f32_16x16x32_bf16 v[188:191], v[100:103], v[152:155], v[188:191]
    v_mfma_f32_16x16x32_bf16 v[188:191], v[104:107], v[148:151], v[188:191]
    v_mfma_f32_16x16x32_bf16 v[188:191], v[108:111], v[144:147], v[188:191]
    v_mfma_f32_16x16x32_bf16 v[188:191], v[112:115], v[140:143], v[188:191]
    v_mfma_f32_16x16x32_bf16 v[188:191], v[116:119], v[136:139], v[188:191]
    v_mfma_f32_16x16x32_bf16 v[188:191], v[120:123], v[132:135], v[188:191]
    v_mfma_f32_16x16x32_bf16 v[188:191], v[124:127], v[128:131], v[188:191]
    s_waitcnt lgkmcnt(0)
    v_mfma_f32_16x16x32_bf16 v[160:163], v[32:35], v[64:67], v[160:163]
    ds_read_b64 v[96:97], v3 offset:192
    v_mfma_f32_16x16x32_bf16 v[164:167], v[32:35], v[68:71], v[164:167]
    ds_read_b64 v[98:99], v3 offset:200
    v_mfma_f32_16x16x32_bf16 v[164:167], v[36:39], v[64:67], v[164:167]
    ds_read_b128 v[128:131], v4 offset:3776
    v_mfma_f32_16x16x32_bf16 v[168:171], v[32:35], v[72:75], v[168:171]
    ds_read_b64 v[100:101], v3 offset:704
    v_mfma_f32_16x16x32_bf16 v[168:171], v[36:39], v[68:71], v[168:171]
    ds_read_b64 v[102:103], v3 offset:712
    v_mfma_f32_16x16x32_bf16 v[168:171], v[40:43], v[64:67], v[168:171]
    ds_read_b128 v[132:135], v4 offset:3264
    v_mfma_f32_16x16x32_bf16 v[172:175], v[32:35], v[76:79], v[172:175]
    ds_read_b64 v[104:105], v3 offset:1216
    v_mfma_f32_16x16x32_bf16 v[172:175], v[36:39], v[72:75], v[172:175]
    ds_read_b64 v[106:107], v3 offset:1224
    v_mfma_f32_16x16x32_bf16 v[172:175], v[40:43], v[68:71], v[172:175]
    ds_read_b128 v[136:139], v4 offset:2752
    v_mfma_f32_16x16x32_bf16 v[172:175], v[44:47], v[64:67], v[172:175]
    ds_read_b64 v[108:109], v3 offset:1728
    v_mfma_f32_16x16x32_bf16 v[176:179], v[32:35], v[80:83], v[176:179]
    ds_read_b64 v[110:111], v3 offset:1736
    v_mfma_f32_16x16x32_bf16 v[176:179], v[36:39], v[76:79], v[176:179]
    ds_read_b128 v[140:143], v4 offset:2240
    v_mfma_f32_16x16x32_bf16 v[176:179], v[40:43], v[72:75], v[176:179]
    ds_read_b64 v[112:113], v3 offset:2240
    v_mfma_f32_16x16x32_bf16 v[176:179], v[44:47], v[68:71], v[176:179]
    ds_read_b64 v[114:115], v3 offset:2248
    v_mfma_f32_16x16x32_bf16 v[176:179], v[48:51], v[64:67], v[176:179]
    ds_read_b128 v[144:147], v4 offset:1728
    v_mfma_f32_16x16x32_bf16 v[180:183], v[32:35], v[84:87], v[180:183]
    ds_read_b64 v[116:117], v3 offset:2752
    v_mfma_f32_16x16x32_bf16 v[180:183], v[36:39], v[80:83], v[180:183]
    ds_read_b64 v[118:119], v3 offset:2760
    v_mfma_f32_16x16x32_bf16 v[180:183], v[40:43], v[76:79], v[180:183]
    ds_read_b128 v[148:151], v4 offset:1216
    v_mfma_f32_16x16x32_bf16 v[180:183], v[44:47], v[72:75], v[180:183]
    ds_read_b64 v[120:121], v3 offset:3264
    v_mfma_f32_16x16x32_bf16 v[180:183], v[48:51], v[68:71], v[180:183]
    ds_read_b64 v[122:123], v3 offset:3272
    v_mfma_f32_16x16x32_bf16 v[180:183], v[52:55], v[64:67], v[180:183]
    ds_read_b128 v[152:155], v4 offset:704
    v_mfma_f32_16x16x32_bf16 v[184:187], v[32:35], v[88:91], v[184:187]
    ds_read_b64 v[124:125], v3 offset:3776
    v_mfma_f32_16x16x32_bf16 v[184:187], v[36:39], v[84:87], v[184:187]
    ds_read_b64 v[126:127], v3 offset:3784
    v_mfma_f32_16x16x32_bf16 v[184:187], v[40:43], v[80:83], v[184:187]
    ds_read_b128 v[156:159], v4 offset:192
    v_mfma_f32_16x16x32_bf16 v[184:187], v[44:47], v[76:79], v[184:187]
    v_mfma_f32_16x16x32_bf16 v[184:187], v[48:51], v[72:75], v[184:187]
    v_mfma_f32_16x16x32_bf16 v[184:187], v[52:55], v[68:71], v[184:187]
    v_mfma_f32_16x16x32_bf16 v[184:187], v[56:59], v[64:67], v[184:187]
    v_mfma_f32_16x16x32_bf16 v[188:191], v[32:35], v[92:95], v[188:191]
    v_mfma_f32_16x16x32_bf16 v[188:191], v[36:39], v[88:91], v[188:191]
    v_mfma_f32_16x16x32_bf16 v[188:191], v[40:43], v[84:87], v[188:191]
    v_mfma_f32_16x16x32_bf16 v[188:191], v[44:47], v[80:83], v[188:191]
    v_mfma_f32_16x16x32_bf16 v[188:191], v[48:51], v[76:79], v[188:191]
    v_mfma_f32_16x16x32_bf16 v[188:191], v[52:55], v[72:75], v[188:191]
    v_mfma_f32_16x16x32_bf16 v[188:191], v[56:59], v[68:71], v[188:191]
    v_mfma_f32_16x16x32_bf16 v[188:191], v[60:63], v[64:67], v[188:191]
    s_waitcnt lgkmcnt(0)
    v_mfma_f32_16x16x32_bf16 v[160:163], v[96:99], v[128:131], v[160:163]
    ds_read_b64 v[32:33], v3 offset:256
    v_mfma_f32_16x16x32_bf16 v[164:167], v[96:99], v[132:135], v[164:167]
    ds_read_b64 v[34:35], v3 offset:264
    v_mfma_f32_16x16x32_bf16 v[164:167], v[100:103], v[128:131], v[164:167]
    ds_read_b128 v[64:67], v4 offset:3840
    v_mfma_f32_16x16x32_bf16 v[168:171], v[96:99], v[136:139], v[168:171]
    ds_read_b64 v[36:37], v3 offset:768
    v_mfma_f32_16x16x32_bf16 v[168:171], v[100:103], v[132:135], v[168:171]
    ds_read_b64 v[38:39], v3 offset:776
    v_mfma_f32_16x16x32_bf16 v[168:171], v[104:107], v[128:131], v[168:171]
    ds_read_b128 v[68:71], v4 offset:3328
    v_mfma_f32_16x16x32_bf16 v[172:175], v[96:99], v[140:143], v[172:175]
    ds_read_b64 v[40:41], v3 offset:1280
    v_mfma_f32_16x16x32_bf16 v[172:175], v[100:103], v[136:139], v[172:175]
    ds_read_b64 v[42:43], v3 offset:1288
    v_mfma_f32_16x16x32_bf16 v[172:175], v[104:107], v[132:135], v[172:175]
    ds_read_b128 v[72:75], v4 offset:2816
    v_mfma_f32_16x16x32_bf16 v[172:175], v[108:111], v[128:131], v[172:175]
    ds_read_b64 v[44:45], v3 offset:1792
    v_mfma_f32_16x16x32_bf16 v[176:179], v[96:99], v[144:147], v[176:179]
    ds_read_b64 v[46:47], v3 offset:1800
    v_mfma_f32_16x16x32_bf16 v[176:179], v[100:103], v[140:143], v[176:179]
    ds_read_b128 v[76:79], v4 offset:2304
    v_mfma_f32_16x16x32_bf16 v[176:179], v[104:107], v[136:139], v[176:179]
    ds_read_b64 v[48:49], v3 offset:2304
    v_mfma_f32_16x16x32_bf16 v[176:179], v[108:111], v[132:135], v[176:179]
    ds_read_b64 v[50:51], v3 offset:2312
    v_mfma_f32_16x16x32_bf16 v[176:179], v[112:115], v[128:131], v[176:179]
    ds_read_b128 v[80:83], v4 offset:1792
    v_mfma_f32_16x16x32_bf16 v[180:183], v[96:99], v[148:151], v[180:183]
    ds_read_b64 v[52:53], v3 offset:2816
    v_mfma_f32_16x16x32_bf16 v[180:183], v[100:103], v[144:147], v[180:183]
    ds_read_b64 v[54:55], v3 offset:2824
    v_mfma_f32_16x16x32_bf16 v[180:183], v[104:107], v[140:143], v[180:183]
    ds_read_b128 v[84:87], v4 offset:1280
    v_mfma_f32_16x16x32_bf16 v[180:183], v[108:111], v[136:139], v[180:183]
    ds_read_b64 v[56:57], v3 offset:3328
    v_mfma_f32_16x16x32_bf16 v[180:183], v[112:115], v[132:135], v[180:183]
    ds_read_b64 v[58:59], v3 offset:3336
    v_mfma_f32_16x16x32_bf16 v[180:183], v[116:119], v[128:131], v[180:183]
    ds_read_b128 v[88:91], v4 offset:768
    v_mfma_f32_16x16x32_bf16 v[184:187], v[96:99], v[152:155], v[184:187]
    ds_read_b64 v[60:61], v3 offset:3840
    v_mfma_f32_16x16x32_bf16 v[184:187], v[100:103], v[148:151], v[184:187]
    ds_read_b64 v[62:63], v3 offset:3848
    v_mfma_f32_16x16x32_bf16 v[184:187], v[104:107], v[144:147], v[184:187]
    ds_read_b128 v[92:95], v4 offset:256
    v_mfma_f32_16x16x32_bf16 v[184:187], v[108:111], v[140:143], v[184:187]
    v_mfma_f32_16x16x32_bf16 v[184:187], v[112:115], v[136:139], v[184:187]
    v_mfma_f32_16x16x32_bf16 v[184:187], v[116:119], v[132:135], v[184:187]
    v_mfma_f32_16x16x32_bf16 v[184:187], v[120:123], v[128:131], v[184:187]
    v_mfma_f32_16x16x32_bf16 v[188:191], v[96:99], v[156:159], v[188:191]
    v_mfma_f32_16x16x32_bf16 v[188:191], v[100:103], v[152:155], v[188:191]
    v_mfma_f32_16x16x32_bf16 v[188:191], v[104:107], v[148:151], v[188:191]
    v_mfma_f32_16x16x32_bf16 v[188:191], v[108:111], v[144:147], v[188:191]
    v_mfma_f32_16x16x32_bf16 v[188:191], v[112:115], v[140:143], v[188:191]
    v_mfma_f32_16x16x32_bf16 v[188:191], v[116:119], v[136:139], v[188:191]
    v_mfma_f32_16x16x32_bf16 v[188:191], v[120:123], v[132:135], v[188:191]
    v_mfma_f32_16x16x32_bf16 v[188:191], v[124:127], v[128:131], v[188:191]
    s_waitcnt lgkmcnt(0)
    v_mfma_f32_16x16x32_bf16 v[160:163], v[32:35], v[64:67], v[160:163]
    ds_read_b64 v[96:97], v3 offset:320
    v_mfma_f32_16x16x32_bf16 v[164:167], v[32:35], v[68:71], v[164:167]
    ds_read_b64 v[98:99], v3 offset:328
    v_mfma_f32_16x16x32_bf16 v[164:167], v[36:39], v[64:67], v[164:167]
    ds_read_b128 v[128:131], v4 offset:3904
    v_mfma_f32_16x16x32_bf16 v[168:171], v[32:35], v[72:75], v[168:171]
    ds_read_b64 v[100:101], v3 offset:832
    v_mfma_f32_16x16x32_bf16 v[168:171], v[36:39], v[68:71], v[168:171]
    ds_read_b64 v[102:103], v3 offset:840
    v_mfma_f32_16x16x32_bf16 v[168:171], v[40:43], v[64:67], v[168:171]
    ds_read_b128 v[132:135], v4 offset:3392
    v_mfma_f32_16x16x32_bf16 v[172:175], v[32:35], v[76:79], v[172:175]
    ds_read_b64 v[104:105], v3 offset:1344
    v_mfma_f32_16x16x32_bf16 v[172:175], v[36:39], v[72:75], v[172:175]
    ds_read_b64 v[106:107], v3 offset:1352
    v_mfma_f32_16x16x32_bf16 v[172:175], v[40:43], v[68:71], v[172:175]
    ds_read_b128 v[136:139], v4 offset:2880
    v_mfma_f32_16x16x32_bf16 v[172:175], v[44:47], v[64:67], v[172:175]
    ds_read_b64 v[108:109], v3 offset:1856
    v_mfma_f32_16x16x32_bf16 v[176:179], v[32:35], v[80:83], v[176:179]
    ds_read_b64 v[110:111], v3 offset:1864
    v_mfma_f32_16x16x32_bf16 v[176:179], v[36:39], v[76:79], v[176:179]
    ds_read_b128 v[140:143], v4 offset:2368
    v_mfma_f32_16x16x32_bf16 v[176:179], v[40:43], v[72:75], v[176:179]
    ds_read_b64 v[112:113], v3 offset:2368
    v_mfma_f32_16x16x32_bf16 v[176:179], v[44:47], v[68:71], v[176:179]
    ds_read_b64 v[114:115], v3 offset:2376
    v_mfma_f32_16x16x32_bf16 v[176:179], v[48:51], v[64:67], v[176:179]
    ds_read_b128 v[144:147], v4 offset:1856
    v_mfma_f32_16x16x32_bf16 v[180:183], v[32:35], v[84:87], v[180:183]
    ds_read_b64 v[116:117], v3 offset:2880
    v_mfma_f32_16x16x32_bf16 v[180:183], v[36:39], v[80:83], v[180:183]
    ds_read_b64 v[118:119], v3 offset:2888
    v_mfma_f32_16x16x32_bf16 v[180:183], v[40:43], v[76:79], v[180:183]
    ds_read_b128 v[148:151], v4 offset:1344
    v_mfma_f32_16x16x32_bf16 v[180:183], v[44:47], v[72:75], v[180:183]
    ds_read_b64 v[120:121], v3 offset:3392
    v_mfma_f32_16x16x32_bf16 v[180:183], v[48:51], v[68:71], v[180:183]
    ds_read_b64 v[122:123], v3 offset:3400
    v_mfma_f32_16x16x32_bf16 v[180:183], v[52:55], v[64:67], v[180:183]
    ds_read_b128 v[152:155], v4 offset:832
    v_mfma_f32_16x16x32_bf16 v[184:187], v[32:35], v[88:91], v[184:187]
    ds_read_b64 v[124:125], v3 offset:3904
    v_mfma_f32_16x16x32_bf16 v[184:187], v[36:39], v[84:87], v[184:187]
    ds_read_b64 v[126:127], v3 offset:3912
    v_mfma_f32_16x16x32_bf16 v[184:187], v[40:43], v[80:83], v[184:187]
    ds_read_b128 v[156:159], v4 offset:320
    v_mfma_f32_16x16x32_bf16 v[184:187], v[44:47], v[76:79], v[184:187]
    v_mfma_f32_16x16x32_bf16 v[184:187], v[48:51], v[72:75], v[184:187]
    v_mfma_f32_16x16x32_bf16 v[184:187], v[52:55], v[68:71], v[184:187]
    v_mfma_f32_16x16x32_bf16 v[184:187], v[56:59], v[64:67], v[184:187]
    v_mfma_f32_16x16x32_bf16 v[188:191], v[32:35], v[92:95], v[188:191]
    v_mfma_f32_16x16x32_bf16 v[188:191], v[36:39], v[88:91], v[188:191]
    v_mfma_f32_16x16x32_bf16 v[188:191], v[40:43], v[84:87], v[188:191]
    v_mfma_f32_16x16x32_bf16 v[188:191], v[44:47], v[80:83], v[188:191]
    v_mfma_f32_16x16x32_bf16 v[188:191], v[48:51], v[76:79], v[188:191]
    v_mfma_f32_16x16x32_bf16 v[188:191], v[52:55], v[72:75], v[188:191]
    v_mfma_f32_16x16x32_bf16 v[188:191], v[56:59], v[68:71], v[188:191]
    v_mfma_f32_16x16x32_bf16 v[188:191], v[60:63], v[64:67], v[188:191]
    s_waitcnt lgkmcnt(0)
    v_mfma_f32_16x16x32_bf16 v[160:163], v[96:99], v[128:131], v[160:163]
    ds_read_b64 v[32:33], v3 offset:384
    v_mfma_f32_16x16x32_bf16 v[164:167], v[96:99], v[132:135], v[164:167]
    ds_read_b64 v[34:35], v3 offset:392
    v_mfma_f32_16x16x32_bf16 v[164:167], v[100:103], v[128:131], v[164:167]
    ds_read_b128 v[64:67], v4 offset:3968
    v_mfma_f32_16x16x32_bf16 v[168:171], v[96:99], v[136:139], v[168:171]
    ds_read_b64 v[36:37], v3 offset:896
    v_mfma_f32_16x16x32_bf16 v[168:171], v[100:103], v[132:135], v[168:171]
    ds_read_b64 v[38:39], v3 offset:904
    v_mfma_f32_16x16x32_bf16 v[168:171], v[104:107], v[128:131], v[168:171]
    ds_read_b128 v[68:71], v4 offset:3456
    v_mfma_f32_16x16x32_bf16 v[172:175], v[96:99], v[140:143], v[172:175]
    ds_read_b64 v[40:41], v3 offset:1408
    v_mfma_f32_16x16x32_bf16 v[172:175], v[100:103], v[136:139], v[172:175]
    ds_read_b64 v[42:43], v3 offset:1416
    v_mfma_f32_16x16x32_bf16 v[172:175], v[104:107], v[132:135], v[172:175]
    ds_read_b128 v[72:75], v4 offset:2944
    v_mfma_f32_16x16x32_bf16 v[172:175], v[108:111], v[128:131], v[172:175]
    ds_read_b64 v[44:45], v3 offset:1920
    v_mfma_f32_16x16x32_bf16 v[176:179], v[96:99], v[144:147], v[176:179]
    ds_read_b64 v[46:47], v3 offset:1928
    v_mfma_f32_16x16x32_bf16 v[176:179], v[100:103], v[140:143], v[176:179]
    ds_read_b128 v[76:79], v4 offset:2432
    v_mfma_f32_16x16x32_bf16 v[176:179], v[104:107], v[136:139], v[176:179]
    ds_read_b64 v[48:49], v3 offset:2432
    v_mfma_f32_16x16x32_bf16 v[176:179], v[108:111], v[132:135], v[176:179]
    ds_read_b64 v[50:51], v3 offset:2440
    v_mfma_f32_16x16x32_bf16 v[176:179], v[112:115], v[128:131], v[176:179]
    ds_read_b128 v[80:83], v4 offset:1920
    v_mfma_f32_16x16x32_bf16 v[180:183], v[96:99], v[148:151], v[180:183]
    ds_read_b64 v[52:53], v3 offset:2944
    v_mfma_f32_16x16x32_bf16 v[180:183], v[100:103], v[144:147], v[180:183]
    ds_read_b64 v[54:55], v3 offset:2952
    v_mfma_f32_16x16x32_bf16 v[180:183], v[104:107], v[140:143], v[180:183]
    ds_read_b128 v[84:87], v4 offset:1408
    v_mfma_f32_16x16x32_bf16 v[180:183], v[108:111], v[136:139], v[180:183]
    ds_read_b64 v[56:57], v3 offset:3456
    v_mfma_f32_16x16x32_bf16 v[180:183], v[112:115], v[132:135], v[180:183]
    ds_read_b64 v[58:59], v3 offset:3464
    v_mfma_f32_16x16x32_bf16 v[180:183], v[116:119], v[128:131], v[180:183]
    ds_read_b128 v[88:91], v4 offset:896
    v_mfma_f32_16x16x32_bf16 v[184:187], v[96:99], v[152:155], v[184:187]
    ds_read_b64 v[60:61], v3 offset:3968
    v_mfma_f32_16x16x32_bf16 v[184:187], v[100:103], v[148:151], v[184:187]
    ds_read_b64 v[62:63], v3 offset:3976
    v_mfma_f32_16x16x32_bf16 v[184:187], v[104:107], v[144:147], v[184:187]
    ds_read_b128 v[92:95], v4 offset:384
    v_mfma_f32_16x16x32_bf16 v[184:187], v[108:111], v[140:143], v[184:187]
    v_mfma_f32_16x16x32_bf16 v[184:187], v[112:115], v[136:139], v[184:187]
    v_mfma_f32_16x16x32_bf16 v[184:187], v[116:119], v[132:135], v[184:187]
    v_mfma_f32_16x16x32_bf16 v[184:187], v[120:123], v[128:131], v[184:187]
    v_mfma_f32_16x16x32_bf16 v[188:191], v[96:99], v[156:159], v[188:191]
    v_mfma_f32_16x16x32_bf16 v[188:191], v[100:103], v[152:155], v[188:191]
    v_mfma_f32_16x16x32_bf16 v[188:191], v[104:107], v[148:151], v[188:191]
    v_mfma_f32_16x16x32_bf16 v[188:191], v[108:111], v[144:147], v[188:191]
    v_mfma_f32_16x16x32_bf16 v[188:191], v[112:115], v[140:143], v[188:191]
    v_mfma_f32_16x16x32_bf16 v[188:191], v[116:119], v[136:139], v[188:191]
    v_mfma_f32_16x16x32_bf16 v[188:191], v[120:123], v[132:135], v[188:191]
    v_mfma_f32_16x16x32_bf16 v[188:191], v[124:127], v[128:131], v[188:191]
    s_waitcnt lgkmcnt(0)
    v_mfma_f32_16x16x32_bf16 v[160:163], v[32:35], v[64:67], v[160:163]
    ds_read_b64 v[96:97], v3 offset:448
    v_mfma_f32_16x16x32_bf16 v[164:167], v[32:35], v[68:71], v[164:167]
    ds_read_b64 v[98:99], v3 offset:456
    v_mfma_f32_16x16x32_bf16 v[164:167], v[36:39], v[64:67], v[164:167]
    ds_read_b128 v[128:131], v4 offset:4032
    v_mfma_f32_16x16x32_bf16 v[168:171], v[32:35], v[72:75], v[168:171]
    ds_read_b64 v[100:101], v3 offset:960
    v_mfma_f32_16x16x32_bf16 v[168:171], v[36:39], v[68:71], v[168:171]
    ds_read_b64 v[102:103], v3 offset:968
    v_mfma_f32_16x16x32_bf16 v[168:171], v[40:43], v[64:67], v[168:171]
    ds_read_b128 v[132:135], v4 offset:3520
    v_mfma_f32_16x16x32_bf16 v[172:175], v[32:35], v[76:79], v[172:175]
    ds_read_b64 v[104:105], v3 offset:1472
    v_mfma_f32_16x16x32_bf16 v[172:175], v[36:39], v[72:75], v[172:175]
    ds_read_b64 v[106:107], v3 offset:1480
    v_mfma_f32_16x16x32_bf16 v[172:175], v[40:43], v[68:71], v[172:175]
    ds_read_b128 v[136:139], v4 offset:3008
    v_mfma_f32_16x16x32_bf16 v[172:175], v[44:47], v[64:67], v[172:175]
    ds_read_b64 v[108:109], v3 offset:1984
    v_mfma_f32_16x16x32_bf16 v[176:179], v[32:35], v[80:83], v[176:179]
    ds_read_b64 v[110:111], v3 offset:1992
    v_mfma_f32_16x16x32_bf16 v[176:179], v[36:39], v[76:79], v[176:179]
    ds_read_b128 v[140:143], v4 offset:2496
    v_mfma_f32_16x16x32_bf16 v[176:179], v[40:43], v[72:75], v[176:179]
    ds_read_b64 v[112:113], v3 offset:2496
    v_mfma_f32_16x16x32_bf16 v[176:179], v[44:47], v[68:71], v[176:179]
    ds_read_b64 v[114:115], v3 offset:2504
    v_mfma_f32_16x16x32_bf16 v[176:179], v[48:51], v[64:67], v[176:179]
    ds_read_b128 v[144:147], v4 offset:1984
    v_mfma_f32_16x16x32_bf16 v[180:183], v[32:35], v[84:87], v[180:183]
    ds_read_b64 v[116:117], v3 offset:3008
    v_mfma_f32_16x16x32_bf16 v[180:183], v[36:39], v[80:83], v[180:183]
    ds_read_b64 v[118:119], v3 offset:3016
    v_mfma_f32_16x16x32_bf16 v[180:183], v[40:43], v[76:79], v[180:183]
    ds_read_b128 v[148:151], v4 offset:1472
    v_mfma_f32_16x16x32_bf16 v[180:183], v[44:47], v[72:75], v[180:183]
    ds_read_b64 v[120:121], v3 offset:3520
    v_mfma_f32_16x16x32_bf16 v[180:183], v[48:51], v[68:71], v[180:183]
    ds_read_b64 v[122:123], v3 offset:3528
    v_mfma_f32_16x16x32_bf16 v[180:183], v[52:55], v[64:67], v[180:183]
    ds_read_b128 v[152:155], v4 offset:960
    v_mfma_f32_16x16x32_bf16 v[184:187], v[32:35], v[88:91], v[184:187]
    ds_read_b64 v[124:125], v3 offset:4032
    v_mfma_f32_16x16x32_bf16 v[184:187], v[36:39], v[84:87], v[184:187]
    ds_read_b64 v[126:127], v3 offset:4040
    v_mfma_f32_16x16x32_bf16 v[184:187], v[40:43], v[80:83], v[184:187]
    ds_read_b128 v[156:159], v4 offset:448
    v_mfma_f32_16x16x32_bf16 v[184:187], v[44:47], v[76:79], v[184:187]
    v_mfma_f32_16x16x32_bf16 v[184:187], v[48:51], v[72:75], v[184:187]
    v_mfma_f32_16x16x32_bf16 v[184:187], v[52:55], v[68:71], v[184:187]
    v_mfma_f32_16x16x32_bf16 v[184:187], v[56:59], v[64:67], v[184:187]
    v_mfma_f32_16x16x32_bf16 v[188:191], v[32:35], v[92:95], v[188:191]
    v_mfma_f32_16x16x32_bf16 v[188:191], v[36:39], v[88:91], v[188:191]
    v_mfma_f32_16x16x32_bf16 v[188:191], v[40:43], v[84:87], v[188:191]
    v_mfma_f32_16x16x32_bf16 v[188:191], v[44:47], v[80:83], v[188:191]
    v_mfma_f32_16x16x32_bf16 v[188:191], v[48:51], v[76:79], v[188:191]
    v_mfma_f32_16x16x32_bf16 v[188:191], v[52:55], v[72:75], v[188:191]
    v_mfma_f32_16x16x32_bf16 v[188:191], v[56:59], v[68:71], v[188:191]
    v_mfma_f32_16x16x32_bf16 v[188:191], v[60:63], v[64:67], v[188:191]
    s_waitcnt lgkmcnt(0)
    v_mfma_f32_16x16x32_bf16 v[160:163], v[96:99], v[128:131], v[160:163]
    v_mfma_f32_16x16x32_bf16 v[164:167], v[96:99], v[132:135], v[164:167]
    v_mfma_f32_16x16x32_bf16 v[164:167], v[100:103], v[128:131], v[164:167]
    v_mfma_f32_16x16x32_bf16 v[168:171], v[96:99], v[136:139], v[168:171]
    v_mfma_f32_16x16x32_bf16 v[168:171], v[100:103], v[132:135], v[168:171]
    v_mfma_f32_16x16x32_bf16 v[168:171], v[104:107], v[128:131], v[168:171]
    v_mfma_f32_16x16x32_bf16 v[172:175], v[96:99], v[140:143], v[172:175]
    v_mfma_f32_16x16x32_bf16 v[172:175], v[100:103], v[136:139], v[172:175]
    v_mfma_f32_16x16x32_bf16 v[172:175], v[104:107], v[132:135], v[172:175]
    v_mfma_f32_16x16x32_bf16 v[172:175], v[108:111], v[128:131], v[172:175]
    v_mfma_f32_16x16x32_bf16 v[176:179], v[96:99], v[144:147], v[176:179]
    v_mfma_f32_16x16x32_bf16 v[176:179], v[100:103], v[140:143], v[176:179]
    v_mfma_f32_16x16x32_bf16 v[176:179], v[104:107], v[136:139], v[176:179]
    v_mfma_f32_16x16x32_bf16 v[176:179], v[108:111], v[132:135], v[176:179]
    v_mfma_f32_16x16x32_bf16 v[176:179], v[112:115], v[128:131], v[176:179]
    v_mfma_f32_16x16x32_bf16 v[180:183], v[96:99], v[148:151], v[180:183]
    v_mfma_f32_16x16x32_bf16 v[180:183], v[100:103], v[144:147], v[180:183]
    v_mfma_f32_16x16x32_bf16 v[180:183], v[104:107], v[140:143], v[180:183]
    v_mfma_f32_16x16x32_bf16 v[180:183], v[108:111], v[136:139], v[180:183]
    v_mfma_f32_16x16x32_bf16 v[180:183], v[112:115], v[132:135], v[180:183]
    v_mfma_f32_16x16x32_bf16 v[180:183], v[116:119], v[128:131], v[180:183]
    v_mfma_f32_16x16x32_bf16 v[184:187], v[96:99], v[152:155], v[184:187]
    v_mfma_f32_16x16x32_bf16 v[184:187], v[100:103], v[148:151], v[184:187]
    v_mfma_f32_16x16x32_bf16 v[184:187], v[104:107], v[144:147], v[184:187]
    v_mfma_f32_16x16x32_bf16 v[184:187], v[108:111], v[140:143], v[184:187]
    v_mfma_f32_16x16x32_bf16 v[184:187], v[112:115], v[136:139], v[184:187]
    v_mfma_f32_16x16x32_bf16 v[184:187], v[116:119], v[132:135], v[184:187]
    v_mfma_f32_16x16x32_bf16 v[184:187], v[120:123], v[128:131], v[184:187]
    v_mfma_f32_16x16x32_bf16 v[188:191], v[96:99], v[156:159], v[188:191]
    v_mfma_f32_16x16x32_bf16 v[188:191], v[100:103], v[152:155], v[188:191]
    v_mfma_f32_16x16x32_bf16 v[188:191], v[104:107], v[148:151], v[188:191]
    v_mfma_f32_16x16x32_bf16 v[188:191], v[108:111], v[144:147], v[188:191]
    v_mfma_f32_16x16x32_bf16 v[188:191], v[112:115], v[140:143], v[188:191]
    v_mfma_f32_16x16x32_bf16 v[188:191], v[116:119], v[136:139], v[188:191]
    v_mfma_f32_16x16x32_bf16 v[188:191], v[120:123], v[132:135], v[188:191]
    v_mfma_f32_16x16x32_bf16 v[188:191], v[124:127], v[128:131], v[188:191]
    v_lshlrev_b32 v12, 5, v10
    v_lshl_add_u32 v12, v11, 3, v12
    s_mul_i32 s19, s18, 4608
    s_add_u32 s19, s19, 504
    v_sub_u32 v13, s19, v12
    ds_read_b64 v[32:33], v13 offset:3584
    ds_read_b64 v[34:35], v13 offset:3072
    ds_read_b64 v[36:37], v13 offset:2560
    ds_read_b64 v[38:39], v13 offset:2048
    ds_read_b64 v[40:41], v13 offset:1536
    ds_read_b64 v[42:43], v13 offset:1024
    ds_read_b64 v[44:45], v13 offset:512
    ds_read_b64 v[46:47], v13 offset:0
    s_barrier
    s_mul_i32 s19, s18, 4112
    s_add_u32 s19, s19, 26624
    v_add_u32 v14, s19, v12
    s_waitcnt lgkmcnt(0)
    v_cvt_pk_bf16_f32 v16, v160, v161
    v_lshlrev_b32 v160, 16, v16
    v_and_b32 v161, 0xffff0000, v16
    v_cvt_pk_bf16_f32 v17, v162, v163
    v_lshlrev_b32 v162, 16, v17
    v_and_b32 v163, 0xffff0000, v17
    v_and_b32 v20, 0xffff0000, v33
    v_lshlrev_b32 v21, 16, v33
    v_and_b32 v22, 0xffff0000, v32
    v_lshlrev_b32 v23, 16, v32
    v_mul_f32 v20, s51, v20
    v_mul_f32 v21, s51, v21
    v_mul_f32 v22, s51, v22
    v_mul_f32 v23, s51, v23
    v_cvt_pk_bf16_f32 v16, v20, v21
    v_lshlrev_b32 v20, 16, v16
    v_and_b32 v21, 0xffff0000, v16
    v_cvt_pk_bf16_f32 v17, v22, v23
    v_lshlrev_b32 v22, 16, v17
    v_and_b32 v23, 0xffff0000, v17
    v_add_f32 v160, v160, v20
    v_add_f32 v161, v161, v21
    v_add_f32 v162, v162, v22
    v_add_f32 v163, v163, v23
    v_cvt_pk_bf16_f32 v32, v160, v161
    v_cvt_pk_bf16_f32 v33, v162, v163
    ds_write_b64 v14, v[32:33] offset:0
    v_cvt_pk_bf16_f32 v16, v164, v165
    v_lshlrev_b32 v164, 16, v16
    v_and_b32 v165, 0xffff0000, v16
    v_cvt_pk_bf16_f32 v17, v166, v167
    v_lshlrev_b32 v166, 16, v17
    v_and_b32 v167, 0xffff0000, v17
    v_and_b32 v20, 0xffff0000, v35
    v_lshlrev_b32 v21, 16, v35
    v_and_b32 v22, 0xffff0000, v34
    v_lshlrev_b32 v23, 16, v34
    v_mul_f32 v20, s51, v20
    v_mul_f32 v21, s51, v21
    v_mul_f32 v22, s51, v22
    v_mul_f32 v23, s51, v23
    v_cvt_pk_bf16_f32 v16, v20, v21
    v_lshlrev_b32 v20, 16, v16
    v_and_b32 v21, 0xffff0000, v16
    v_cvt_pk_bf16_f32 v17, v22, v23
    v_lshlrev_b32 v22, 16, v17
    v_and_b32 v23, 0xffff0000, v17
    v_add_f32 v164, v164, v20
    v_add_f32 v165, v165, v21
    v_add_f32 v166, v166, v22
    v_add_f32 v167, v167, v23
    v_cvt_pk_bf16_f32 v34, v164, v165
    v_cvt_pk_bf16_f32 v35, v166, v167
    ds_write_b64 v14, v[34:35] offset:512
    v_cvt_pk_bf16_f32 v16, v168, v169
    v_lshlrev_b32 v168, 16, v16
    v_and_b32 v169, 0xffff0000, v16
    v_cvt_pk_bf16_f32 v17, v170, v171
    v_lshlrev_b32 v170, 16, v17
    v_and_b32 v171, 0xffff0000, v17
    v_and_b32 v20, 0xffff0000, v37
    v_lshlrev_b32 v21, 16, v37
    v_and_b32 v22, 0xffff0000, v36
    v_lshlrev_b32 v23, 16, v36
    v_mul_f32 v20, s51, v20
    v_mul_f32 v21, s51, v21
    v_mul_f32 v22, s51, v22
    v_mul_f32 v23, s51, v23
    v_cvt_pk_bf16_f32 v16, v20, v21
    v_lshlrev_b32 v20, 16, v16
    v_and_b32 v21, 0xffff0000, v16
    v_cvt_pk_bf16_f32 v17, v22, v23
    v_lshlrev_b32 v22, 16, v17
    v_and_b32 v23, 0xffff0000, v17
    v_add_f32 v168, v168, v20
    v_add_f32 v169, v169, v21
    v_add_f32 v170, v170, v22
    v_add_f32 v171, v171, v23
    v_cvt_pk_bf16_f32 v36, v168, v169
    v_cvt_pk_bf16_f32 v37, v170, v171
    ds_write_b64 v14, v[36:37] offset:1024
    v_cvt_pk_bf16_f32 v16, v172, v173
    v_lshlrev_b32 v172, 16, v16
    v_and_b32 v173, 0xffff0000, v16
    v_cvt_pk_bf16_f32 v17, v174, v175
    v_lshlrev_b32 v174, 16, v17
    v_and_b32 v175, 0xffff0000, v17
    v_and_b32 v20, 0xffff0000, v39
    v_lshlrev_b32 v21, 16, v39
    v_and_b32 v22, 0xffff0000, v38
    v_lshlrev_b32 v23, 16, v38
    v_mul_f32 v20, s51, v20
    v_mul_f32 v21, s51, v21
    v_mul_f32 v22, s51, v22
    v_mul_f32 v23, s51, v23
    v_cvt_pk_bf16_f32 v16, v20, v21
    v_lshlrev_b32 v20, 16, v16
    v_and_b32 v21, 0xffff0000, v16
    v_cvt_pk_bf16_f32 v17, v22, v23
    v_lshlrev_b32 v22, 16, v17
    v_and_b32 v23, 0xffff0000, v17
    v_add_f32 v172, v172, v20
    v_add_f32 v173, v173, v21
    v_add_f32 v174, v174, v22
    v_add_f32 v175, v175, v23
    v_cvt_pk_bf16_f32 v38, v172, v173
    v_cvt_pk_bf16_f32 v39, v174, v175
    ds_write_b64 v14, v[38:39] offset:1536
    v_cvt_pk_bf16_f32 v16, v176, v177
    v_lshlrev_b32 v176, 16, v16
    v_and_b32 v177, 0xffff0000, v16
    v_cvt_pk_bf16_f32 v17, v178, v179
    v_lshlrev_b32 v178, 16, v17
    v_and_b32 v179, 0xffff0000, v17
    v_and_b32 v20, 0xffff0000, v41
    v_lshlrev_b32 v21, 16, v41
    v_and_b32 v22, 0xffff0000, v40
    v_lshlrev_b32 v23, 16, v40
    v_mul_f32 v20, s51, v20
    v_mul_f32 v21, s51, v21
    v_mul_f32 v22, s51, v22
    v_mul_f32 v23, s51, v23
    v_cvt_pk_bf16_f32 v16, v20, v21
    v_lshlrev_b32 v20, 16, v16
    v_and_b32 v21, 0xffff0000, v16
    v_cvt_pk_bf16_f32 v17, v22, v23
    v_lshlrev_b32 v22, 16, v17
    v_and_b32 v23, 0xffff0000, v17
    v_add_f32 v176, v176, v20
    v_add_f32 v177, v177, v21
    v_add_f32 v178, v178, v22
    v_add_f32 v179, v179, v23
    v_cvt_pk_bf16_f32 v40, v176, v177
    v_cvt_pk_bf16_f32 v41, v178, v179
    ds_write_b64 v14, v[40:41] offset:2048
    v_cvt_pk_bf16_f32 v16, v180, v181
    v_lshlrev_b32 v180, 16, v16
    v_and_b32 v181, 0xffff0000, v16
    v_cvt_pk_bf16_f32 v17, v182, v183
    v_lshlrev_b32 v182, 16, v17
    v_and_b32 v183, 0xffff0000, v17
    v_and_b32 v20, 0xffff0000, v43
    v_lshlrev_b32 v21, 16, v43
    v_and_b32 v22, 0xffff0000, v42
    v_lshlrev_b32 v23, 16, v42
    v_mul_f32 v20, s51, v20
    v_mul_f32 v21, s51, v21
    v_mul_f32 v22, s51, v22
    v_mul_f32 v23, s51, v23
    v_cvt_pk_bf16_f32 v16, v20, v21
    v_lshlrev_b32 v20, 16, v16
    v_and_b32 v21, 0xffff0000, v16
    v_cvt_pk_bf16_f32 v17, v22, v23
    v_lshlrev_b32 v22, 16, v17
    v_and_b32 v23, 0xffff0000, v17
    v_add_f32 v180, v180, v20
    v_add_f32 v181, v181, v21
    v_add_f32 v182, v182, v22
    v_add_f32 v183, v183, v23
    v_cvt_pk_bf16_f32 v42, v180, v181
    v_cvt_pk_bf16_f32 v43, v182, v183
    ds_write_b64 v14, v[42:43] offset:2560
    v_cvt_pk_bf16_f32 v16, v184, v185
    v_lshlrev_b32 v184, 16, v16
    v_and_b32 v185, 0xffff0000, v16
    v_cvt_pk_bf16_f32 v17, v186, v187
    v_lshlrev_b32 v186, 16, v17
    v_and_b32 v187, 0xffff0000, v17
    v_and_b32 v20, 0xffff0000, v45
    v_lshlrev_b32 v21, 16, v45
    v_and_b32 v22, 0xffff0000, v44
    v_lshlrev_b32 v23, 16, v44
    v_mul_f32 v20, s51, v20
    v_mul_f32 v21, s51, v21
    v_mul_f32 v22, s51, v22
    v_mul_f32 v23, s51, v23
    v_cvt_pk_bf16_f32 v16, v20, v21
    v_lshlrev_b32 v20, 16, v16
    v_and_b32 v21, 0xffff0000, v16
    v_cvt_pk_bf16_f32 v17, v22, v23
    v_lshlrev_b32 v22, 16, v17
    v_and_b32 v23, 0xffff0000, v17
    v_add_f32 v184, v184, v20
    v_add_f32 v185, v185, v21
    v_add_f32 v186, v186, v22
    v_add_f32 v187, v187, v23
    v_cvt_pk_bf16_f32 v44, v184, v185
    v_cvt_pk_bf16_f32 v45, v186, v187
    ds_write_b64 v14, v[44:45] offset:3072
    v_cvt_pk_bf16_f32 v16, v188, v189
    v_lshlrev_b32 v188, 16, v16
    v_and_b32 v189, 0xffff0000, v16
    v_cvt_pk_bf16_f32 v17, v190, v191
    v_lshlrev_b32 v190, 16, v17
    v_and_b32 v191, 0xffff0000, v17
    v_and_b32 v20, 0xffff0000, v47
    v_lshlrev_b32 v21, 16, v47
    v_and_b32 v22, 0xffff0000, v46
    v_lshlrev_b32 v23, 16, v46
    v_mul_f32 v20, s51, v20
    v_mul_f32 v21, s51, v21
    v_mul_f32 v22, s51, v22
    v_mul_f32 v23, s51, v23
    v_cvt_pk_bf16_f32 v16, v20, v21
    v_lshlrev_b32 v20, 16, v16
    v_and_b32 v21, 0xffff0000, v16
    v_cvt_pk_bf16_f32 v17, v22, v23
    v_lshlrev_b32 v22, 16, v17
    v_and_b32 v23, 0xffff0000, v17
    v_add_f32 v188, v188, v20
    v_add_f32 v189, v189, v21
    v_add_f32 v190, v190, v22
    v_add_f32 v191, v191, v23
    v_cvt_pk_bf16_f32 v46, v188, v189
    v_cvt_pk_bf16_f32 v47, v190, v191
    ds_write_b64 v14, v[46:47] offset:3584
    s_waitcnt lgkmcnt(0)
    s_barrier
    v_and_b32 v12, 3, v0
    v_lshrrev_b32 v13, 2, v0
    v_mul_u32_u24 v14, 4112, v12
    v_lshl_add_u32 v14, v13, 4, v14
    v_add_u32 v14, 26624, v14
    ds_read_b128 v[32:35], v14 offset:0
    ds_read_b128 v[36:39], v14 offset:1024
    ds_read_b128 v[40:43], v14 offset:2048
    ds_read_b128 v[44:47], v14 offset:3072
    s_add_u32 s4, s34, 0x100000
    s_addc_u32 s5, s35, 0
    s_mov_b32 s6, 0x400000
    s_mov_b32 s7, 0x00020000
    v_lshlrev_b32 v15, 14, v13
    v_lshl_add_u32 v15, v12, 4, v15
    s_lshl_b32 s19, s16, 6
    s_waitcnt lgkmcnt(3)
    s_add_u32 s50, s19, 0
    buffer_store_dwordx4 v[32:35], v15, s[4:7], s50 offen
    s_waitcnt lgkmcnt(2)
    s_add_u32 s50, s19, 1048576
    buffer_store_dwordx4 v[36:39], v15, s[4:7], s50 offen
    s_waitcnt lgkmcnt(1)
    s_add_u32 s50, s19, 2097152
    buffer_store_dwordx4 v[40:43], v15, s[4:7], s50 offen
    s_waitcnt lgkmcnt(0)
    s_add_u32 s50, s19, 3145728
    buffer_store_dwordx4 v[44:47], v15, s[4:7], s50 offen
    s_endpgm
Lcv_pf:
    v_subrev_u32 v0, 256, v0
    s_cmp_lt_u32 s2, 192
    s_cbranch_scc1 Lcv_gemv
    s_load_dwordx2 s[24:25], s[0:1], 0
    s_sub_u32 s56, s2, 192
    s_lshl_b32 s56, s56, 16
    v_lshlrev_b32 v6, 7, v0
    s_waitcnt lgkmcnt(0)
    s_mov_b32 s4, s24
    s_mov_b32 s5, s25
    s_mov_b32 s6, 0x400000
    s_mov_b32 s7, 0x00020000
    buffer_load_dword v20, v6, s[4:7], s56 offen
    s_add_u32 s56, s56, 32768
    buffer_load_dword v21, v6, s[4:7], s56 offen
    s_barrier
    s_barrier
    s_endpgm
Lcv_gemv:
    s_load_dwordx4 s[36:39], s[0:1], 80
    s_cmp_ge_u32 s2, 96
    s_cselect_b32 s41, 1, 0
    s_mul_i32 s42, s41, 96
    s_sub_u32 s42, s2, s42
    v_lshrrev_b32 v9, 3, v0
    s_movk_i32 s19, 12288
    v_mul_lo_u32 v7, v9, s19
    v_and_b32 v8, 7, v0
    v_lshl_add_u32 v7, v8, 4, v7
    s_mul_i32 s43, s41, 6291456
    s_lshl_b32 s19, s42, 7
    s_add_u32 s43, s43, s19
    v_lshlrev_b32 v4, 1, v9
    s_lshl_b32 s19, s41, 10
    s_waitcnt lgkmcnt(0)
    s_mov_b32 s20, s38
    s_mov_b32 s21, s39
    s_mov_b32 s22, 0xc00000
    s_mov_b32 s23, 0x00020000
    s_mov_b32 s52, s36
    s_mov_b32 s53, s37
    s_mov_b32 s54, 0x800
    s_mov_b32 s55, 0x00020000
    buffer_load_ushort v60, v4, s[52:55], s19 offen offset:0
    buffer_load_ushort v61, v4, s[52:55], s19 offen offset:64
    buffer_load_ushort v62, v4, s[52:55], s19 offen offset:128
    buffer_load_ushort v63, v4, s[52:55], s19 offen offset:192
    buffer_load_ushort v64, v4, s[52:55], s19 offen offset:256
    buffer_load_ushort v65, v4, s[52:55], s19 offen offset:320
    buffer_load_ushort v66, v4, s[52:55], s19 offen offset:384
    buffer_load_ushort v67, v4, s[52:55], s19 offen offset:448
    buffer_load_ushort v68, v4, s[52:55], s19 offen offset:512
    buffer_load_ushort v69, v4, s[52:55], s19 offen offset:576
    buffer_load_ushort v70, v4, s[52:55], s19 offen offset:640
    buffer_load_ushort v71, v4, s[52:55], s19 offen offset:704
    buffer_load_ushort v72, v4, s[52:55], s19 offen offset:768
    buffer_load_ushort v73, v4, s[52:55], s19 offen offset:832
    buffer_load_ushort v74, v4, s[52:55], s19 offen offset:896
    buffer_load_ushort v75, v4, s[52:55], s19 offen offset:960
    s_add_u32 s50, s43, 0
    buffer_load_dwordx4 v[96:99], v7, s[20:23], s50 offen
    s_add_u32 s50, s43, 393216
    buffer_load_dwordx4 v[100:103], v7, s[20:23], s50 offen
    s_add_u32 s50, s43, 786432
    buffer_load_dwordx4 v[104:107], v7, s[20:23], s50 offen
    s_add_u32 s50, s43, 1179648
    buffer_load_dwordx4 v[108:111], v7, s[20:23], s50 offen
    s_add_u32 s50, s43, 1572864
    buffer_load_dwordx4 v[112:115], v7, s[20:23], s50 offen
    s_add_u32 s50, s43, 1966080
    buffer_load_dwordx4 v[116:119], v7, s[20:23], s50 offen
    s_add_u32 s50, s43, 2359296
    buffer_load_dwordx4 v[120:123], v7, s[20:23], s50 offen
    s_add_u32 s50, s43, 2752512
    buffer_load_dwordx4 v[124:127], v7, s[20:23], s50 offen
    s_add_u32 s50, s43, 3145728
    buffer_load_dwordx4 v[128:131], v7, s[20:23], s50 offen
    s_add_u32 s50, s43, 3538944
    buffer_load_dwordx4 v[132:135], v7, s[20:23], s50 offen
    s_add_u32 s50, s43, 3932160
    buffer_load_dwordx4 v[136:139], v7, s[20:23], s50 offen
    s_add_u32 s50, s43, 4325376
    buffer_load_dwordx4 v[140:143], v7, s[20:23], s50 offen
    s_add_u32 s50, s43, 4718592
    buffer_load_dwordx4 v[144:147], v7, s[20:23], s50 offen
    s_add_u32 s50, s43, 5111808
    buffer_load_dwordx4 v[148:151], v7, s[20:23], s50 offen
    s_add_u32 s50, s43, 5505024
    buffer_load_dwordx4 v[152:155], v7, s[20:23], s50 offen
    s_add_u32 s50, s43, 5898240
    buffer_load_dwordx4 v[156:159], v7, s[20:23], s50 offen
    s_waitcnt vmcnt(16)
    v_lshlrev_b32 v60, 16, v60
    v_lshlrev_b32 v61, 16, v61
    v_lshlrev_b32 v62, 16, v62
    v_lshlrev_b32 v63, 16, v63
    v_lshlrev_b32 v64, 16, v64
    v_lshlrev_b32 v65, 16, v65
    v_lshlrev_b32 v66, 16, v66
    v_lshlrev_b32 v67, 16, v67
    v_lshlrev_b32 v68, 16, v68
    v_lshlrev_b32 v69, 16, v69
    v_lshlrev_b32 v70, 16, v70
    v_lshlrev_b32 v71, 16, v71
    v_lshlrev_b32 v72, 16, v72
    v_lshlrev_b32 v73, 16, v73
    v_lshlrev_b32 v74, 16, v74
    v_lshlrev_b32 v75, 16, v75
    v_mul_f32 v32, 0xbfb8aa3b, v60
    v_mul_f32 v33, 0xbfb8aa3b, v61
    v_mul_f32 v34, 0xbfb8aa3b, v62
    v_mul_f32 v35, 0xbfb8aa3b, v63
    v_mul_f32 v36, 0xbfb8aa3b, v64
    v_mul_f32 v37, 0xbfb8aa3b, v65
    v_mul_f32 v38, 0xbfb8aa3b, v66
    v_mul_f32 v39, 0xbfb8aa3b, v67
    v_mul_f32 v40, 0xbfb8aa3b, v68
    v_mul_f32 v41, 0xbfb8aa3b, v69
    v_mul_f32 v42, 0xbfb8aa3b, v70
    v_mul_f32 v43, 0xbfb8aa3b, v71
    v_mul_f32 v44, 0xbfb8aa3b, v72
    v_mul_f32 v45, 0xbfb8aa3b, v73
    v_mul_f32 v46, 0xbfb8aa3b, v74
    v_mul_f32 v47, 0xbfb8aa3b, v75
    v_exp_f32 v32, v32
    v_exp_f32 v33, v33
    v_exp_f32 v34, v34
    v_exp_f32 v35, v35
    v_exp_f32 v36, v36
    v_exp_f32 v37, v37
    v_exp_f32 v38, v38
    v_exp_f32 v39, v39
    v_exp_f32 v40, v40
    v_exp_f32 v41, v41
    v_exp_f32 v42, v42
    v_exp_f32 v43, v43
    v_exp_f32 v44, v44
    v_exp_f32 v45, v45
    v_exp_f32 v46, v46
    v_exp_f32 v47, v47
    v_add_f32 v32, 1.0, v32
    v_add_f32 v33, 1.0, v33
    v_add_f32 v34, 1.0, v34
    v_add_f32 v35, 1.0, v35
    v_add_f32 v36, 1.0, v36
    v_add_f32 v37, 1.0, v37
    v_add_f32 v38, 1.0, v38
    v_add_f32 v39, 1.0, v39
    v_add_f32 v40, 1.0, v40
    v_add_f32 v41, 1.0, v41
    v_add_f32 v42, 1.0, v42
    v_add_f32 v43, 1.0, v43
    v_add_f32 v44, 1.0, v44
    v_add_f32 v45, 1.0, v45
    v_add_f32 v46, 1.0, v46
    v_add_f32 v47, 1.0, v47
    v_rcp_f32 v32, v32
    v_rcp_f32 v33, v33
    v_rcp_f32 v34, v34
    v_rcp_f32 v35, v35
    v_rcp_f32 v36, v36
    v_rcp_f32 v37, v37
    v_rcp_f32 v38, v38
    v_rcp_f32 v39, v39
    v_rcp_f32 v40, v40
    v_rcp_f32 v41, v41
    v_rcp_f32 v42, v42
    v_rcp_f32 v43, v43
    v_rcp_f32 v44, v44
    v_rcp_f32 v45, v45
    v_rcp_f32 v46, v46
    v_rcp_f32 v47, v47
    v_mul_f32 v60, v60, v32
    v_mul_f32 v61, v61, v33
    v_mul_f32 v62, v62, v34
    v_mul_f32 v63, v63, v35
    v_mul_f32 v64, v64, v36
    v_mul_f32 v65, v65, v37
    v_mul_f32 v66, v66, v38
    v_mul_f32 v67, v67, v39
    v_mul_f32 v68, v68, v40
    v_mul_f32 v69, v69, v41
    v_mul_f32 v70, v70, v42
    v_mul_f32 v71, v71, v43
    v_mul_f32 v72, v72, v44
    v_mul_f32 v73, v73, v45
    v_mul_f32 v74, v74, v46
    v_mul_f32 v75, v75, v47
    v_cvt_pk_bf16_f32 v32, v60, v61
    v_lshlrev_b32 v60, 16, v32
    v_and_b32 v61, 0xffff0000, v32
    v_cvt_pk_bf16_f32 v34, v62, v63
    v_lshlrev_b32 v62, 16, v34
    v_and_b32 v63, 0xffff0000, v34
    v_cvt_pk_bf16_f32 v36, v64, v65
    v_lshlrev_b32 v64, 16, v36
    v_and_b32 v65, 0xffff0000, v36
    v_cvt_pk_bf16_f32 v38, v66, v67
    v_lshlrev_b32 v66, 16, v38
    v_and_b32 v67, 0xffff0000, v38
    v_cvt_pk_bf16_f32 v40, v68, v69
    v_lshlrev_b32 v68, 16, v40
    v_and_b32 v69, 0xffff0000, v40
    v_cvt_pk_bf16_f32 v42, v70, v71
    v_lshlrev_b32 v70, 16, v42
    v_and_b32 v71, 0xffff0000, v42
    v_cvt_pk_bf16_f32 v44, v72, v73
    v_lshlrev_b32 v72, 16, v44
    v_and_b32 v73, 0xffff0000, v44
    v_cvt_pk_bf16_f32 v46, v74, v75
    v_lshlrev_b32 v74, 16, v46
    v_and_b32 v75, 0xffff0000, v46
    v_mov_b32 v80, 0
    v_mov_b32 v81, 0
    v_mov_b32 v82, 0
    v_mov_b32 v83, 0
    v_mov_b32 v84, 0
    v_mov_b32 v85, 0
    v_mov_b32 v86, 0
    v_mov_b32 v87, 0
    s_waitcnt vmcnt(15)
    v_lshlrev_b32 v12, 16, v96
    v_and_b32 v13, 0xffff0000, v96
    v_fmac_f32 v80, v60, v12
    v_fmac_f32 v81, v60, v13
    v_lshlrev_b32 v12, 16, v97
    v_and_b32 v13, 0xffff0000, v97
    v_fmac_f32 v82, v60, v12
    v_fmac_f32 v83, v60, v13
    v_lshlrev_b32 v12, 16, v98
    v_and_b32 v13, 0xffff0000, v98
    v_fmac_f32 v84, v60, v12
    v_fmac_f32 v85, v60, v13
    v_lshlrev_b32 v12, 16, v99
    v_and_b32 v13, 0xffff0000, v99
    v_fmac_f32 v86, v60, v12
    v_fmac_f32 v87, v60, v13
    s_waitcnt vmcnt(14)
    v_lshlrev_b32 v12, 16, v100
    v_and_b32 v13, 0xffff0000, v100
    v_fmac_f32 v80, v61, v12
    v_fmac_f32 v81, v61, v13
    v_lshlrev_b32 v12, 16, v101
    v_and_b32 v13, 0xffff0000, v101
    v_fmac_f32 v82, v61, v12
    v_fmac_f32 v83, v61, v13
    v_lshlrev_b32 v12, 16, v102
    v_and_b32 v13, 0xffff0000, v102
    v_fmac_f32 v84, v61, v12
    v_fmac_f32 v85, v61, v13
    v_lshlrev_b32 v12, 16, v103
    v_and_b32 v13, 0xffff0000, v103
    v_fmac_f32 v86, v61, v12
    v_fmac_f32 v87, v61, v13
    s_waitcnt vmcnt(13)
    v_lshlrev_b32 v12, 16, v104
    v_and_b32 v13, 0xffff0000, v104
    v_fmac_f32 v80, v62, v12
    v_fmac_f32 v81, v62, v13
    v_lshlrev_b32 v12, 16, v105
    v_and_b32 v13, 0xffff0000, v105
    v_fmac_f32 v82, v62, v12
    v_fmac_f32 v83, v62, v13
    v_lshlrev_b32 v12, 16, v106
    v_and_b32 v13, 0xffff0000, v106
    v_fmac_f32 v84, v62, v12
    v_fmac_f32 v85, v62, v13
    v_lshlrev_b32 v12, 16, v107
    v_and_b32 v13, 0xffff0000, v107
    v_fmac_f32 v86, v62, v12
    v_fmac_f32 v87, v62, v13
    s_waitcnt vmcnt(12)
    v_lshlrev_b32 v12, 16, v108
    v_and_b32 v13, 0xffff0000, v108
    v_fmac_f32 v80, v63, v12
    v_fmac_f32 v81, v63, v13
    v_lshlrev_b32 v12, 16, v109
    v_and_b32 v13, 0xffff0000, v109
    v_fmac_f32 v82, v63, v12
    v_fmac_f32 v83, v63, v13
    v_lshlrev_b32 v12, 16, v110
    v_and_b32 v13, 0xffff0000, v110
    v_fmac_f32 v84, v63, v12
    v_fmac_f32 v85, v63, v13
    v_lshlrev_b32 v12, 16, v111
    v_and_b32 v13, 0xffff0000, v111
    v_fmac_f32 v86, v63, v12
    v_fmac_f32 v87, v63, v13
    s_waitcnt vmcnt(11)
    v_lshlrev_b32 v12, 16, v112
    v_and_b32 v13, 0xffff0000, v112
    v_fmac_f32 v80, v64, v12
    v_fmac_f32 v81, v64, v13
    v_lshlrev_b32 v12, 16, v113
    v_and_b32 v13, 0xffff0000, v113
    v_fmac_f32 v82, v64, v12
    v_fmac_f32 v83, v64, v13
    v_lshlrev_b32 v12, 16, v114
    v_and_b32 v13, 0xffff0000, v114
    v_fmac_f32 v84, v64, v12
    v_fmac_f32 v85, v64, v13
    v_lshlrev_b32 v12, 16, v115
    v_and_b32 v13, 0xffff0000, v115
    v_fmac_f32 v86, v64, v12
    v_fmac_f32 v87, v64, v13
    s_waitcnt vmcnt(10)
    v_lshlrev_b32 v12, 16, v116
    v_and_b32 v13, 0xffff0000, v116
    v_fmac_f32 v80, v65, v12
    v_fmac_f32 v81, v65, v13
    v_lshlrev_b32 v12, 16, v117
    v_and_b32 v13, 0xffff0000, v117
    v_fmac_f32 v82, v65, v12
    v_fmac_f32 v83, v65, v13
    v_lshlrev_b32 v12, 16, v118
    v_and_b32 v13, 0xffff0000, v118
    v_fmac_f32 v84, v65, v12
    v_fmac_f32 v85, v65, v13
    v_lshlrev_b32 v12, 16, v119
    v_and_b32 v13, 0xffff0000, v119
    v_fmac_f32 v86, v65, v12
    v_fmac_f32 v87, v65, v13
    s_waitcnt vmcnt(9)
    v_lshlrev_b32 v12, 16, v120
    v_and_b32 v13, 0xffff0000, v120
    v_fmac_f32 v80, v66, v12
    v_fmac_f32 v81, v66, v13
    v_lshlrev_b32 v12, 16, v121
    v_and_b32 v13, 0xffff0000, v121
    v_fmac_f32 v82, v66, v12
    v_fmac_f32 v83, v66, v13
    v_lshlrev_b32 v12, 16, v122
    v_and_b32 v13, 0xffff0000, v122
    v_fmac_f32 v84, v66, v12
    v_fmac_f32 v85, v66, v13
    v_lshlrev_b32 v12, 16, v123
    v_and_b32 v13, 0xffff0000, v123
    v_fmac_f32 v86, v66, v12
    v_fmac_f32 v87, v66, v13
    s_waitcnt vmcnt(8)
    v_lshlrev_b32 v12, 16, v124
    v_and_b32 v13, 0xffff0000, v124
    v_fmac_f32 v80, v67, v12
    v_fmac_f32 v81, v67, v13
    v_lshlrev_b32 v12, 16, v125
    v_and_b32 v13, 0xffff0000, v125
    v_fmac_f32 v82, v67, v12
    v_fmac_f32 v83, v67, v13
    v_lshlrev_b32 v12, 16, v126
    v_and_b32 v13, 0xffff0000, v126
    v_fmac_f32 v84, v67, v12
    v_fmac_f32 v85, v67, v13
    v_lshlrev_b32 v12, 16, v127
    v_and_b32 v13, 0xffff0000, v127
    v_fmac_f32 v86, v67, v12
    v_fmac_f32 v87, v67, v13
    s_waitcnt vmcnt(7)
    v_lshlrev_b32 v12, 16, v128
    v_and_b32 v13, 0xffff0000, v128
    v_fmac_f32 v80, v68, v12
    v_fmac_f32 v81, v68, v13
    v_lshlrev_b32 v12, 16, v129
    v_and_b32 v13, 0xffff0000, v129
    v_fmac_f32 v82, v68, v12
    v_fmac_f32 v83, v68, v13
    v_lshlrev_b32 v12, 16, v130
    v_and_b32 v13, 0xffff0000, v130
    v_fmac_f32 v84, v68, v12
    v_fmac_f32 v85, v68, v13
    v_lshlrev_b32 v12, 16, v131
    v_and_b32 v13, 0xffff0000, v131
    v_fmac_f32 v86, v68, v12
    v_fmac_f32 v87, v68, v13
    s_waitcnt vmcnt(6)
    v_lshlrev_b32 v12, 16, v132
    v_and_b32 v13, 0xffff0000, v132
    v_fmac_f32 v80, v69, v12
    v_fmac_f32 v81, v69, v13
    v_lshlrev_b32 v12, 16, v133
    v_and_b32 v13, 0xffff0000, v133
    v_fmac_f32 v82, v69, v12
    v_fmac_f32 v83, v69, v13
    v_lshlrev_b32 v12, 16, v134
    v_and_b32 v13, 0xffff0000, v134
    v_fmac_f32 v84, v69, v12
    v_fmac_f32 v85, v69, v13
    v_lshlrev_b32 v12, 16, v135
    v_and_b32 v13, 0xffff0000, v135
    v_fmac_f32 v86, v69, v12
    v_fmac_f32 v87, v69, v13
    s_waitcnt vmcnt(5)
    v_lshlrev_b32 v12, 16, v136
    v_and_b32 v13, 0xffff0000, v136
    v_fmac_f32 v80, v70, v12
    v_fmac_f32 v81, v70, v13
    v_lshlrev_b32 v12, 16, v137
    v_and_b32 v13, 0xffff0000, v137
    v_fmac_f32 v82, v70, v12
    v_fmac_f32 v83, v70, v13
    v_lshlrev_b32 v12, 16, v138
    v_and_b32 v13, 0xffff0000, v138
    v_fmac_f32 v84, v70, v12
    v_fmac_f32 v85, v70, v13
    v_lshlrev_b32 v12, 16, v139
    v_and_b32 v13, 0xffff0000, v139
    v_fmac_f32 v86, v70, v12
    v_fmac_f32 v87, v70, v13
    s_waitcnt vmcnt(4)
    v_lshlrev_b32 v12, 16, v140
    v_and_b32 v13, 0xffff0000, v140
    v_fmac_f32 v80, v71, v12
    v_fmac_f32 v81, v71, v13
    v_lshlrev_b32 v12, 16, v141
    v_and_b32 v13, 0xffff0000, v141
    v_fmac_f32 v82, v71, v12
    v_fmac_f32 v83, v71, v13
    v_lshlrev_b32 v12, 16, v142
    v_and_b32 v13, 0xffff0000, v142
    v_fmac_f32 v84, v71, v12
    v_fmac_f32 v85, v71, v13
    v_lshlrev_b32 v12, 16, v143
    v_and_b32 v13, 0xffff0000, v143
    v_fmac_f32 v86, v71, v12
    v_fmac_f32 v87, v71, v13
    s_waitcnt vmcnt(3)
    v_lshlrev_b32 v12, 16, v144
    v_and_b32 v13, 0xffff0000, v144
    v_fmac_f32 v80, v72, v12
    v_fmac_f32 v81, v72, v13
    v_lshlrev_b32 v12, 16, v145
    v_and_b32 v13, 0xffff0000, v145
    v_fmac_f32 v82, v72, v12
    v_fmac_f32 v83, v72, v13
    v_lshlrev_b32 v12, 16, v146
    v_and_b32 v13, 0xffff0000, v146
    v_fmac_f32 v84, v72, v12
    v_fmac_f32 v85, v72, v13
    v_lshlrev_b32 v12, 16, v147
    v_and_b32 v13, 0xffff0000, v147
    v_fmac_f32 v86, v72, v12
    v_fmac_f32 v87, v72, v13
    s_waitcnt vmcnt(2)
    v_lshlrev_b32 v12, 16, v148
    v_and_b32 v13, 0xffff0000, v148
    v_fmac_f32 v80, v73, v12
    v_fmac_f32 v81, v73, v13
    v_lshlrev_b32 v12, 16, v149
    v_and_b32 v13, 0xffff0000, v149
    v_fmac_f32 v82, v73, v12
    v_fmac_f32 v83, v73, v13
    v_lshlrev_b32 v12, 16, v150
    v_and_b32 v13, 0xffff0000, v150
    v_fmac_f32 v84, v73, v12
    v_fmac_f32 v85, v73, v13
    v_lshlrev_b32 v12, 16, v151
    v_and_b32 v13, 0xffff0000, v151
    v_fmac_f32 v86, v73, v12
    v_fmac_f32 v87, v73, v13
    s_waitcnt vmcnt(1)
    v_lshlrev_b32 v12, 16, v152
    v_and_b32 v13, 0xffff0000, v152
    v_fmac_f32 v80, v74, v12
    v_fmac_f32 v81, v74, v13
    v_lshlrev_b32 v12, 16, v153
    v_and_b32 v13, 0xffff0000, v153
    v_fmac_f32 v82, v74, v12
    v_fmac_f32 v83, v74, v13
    v_lshlrev_b32 v12, 16, v154
    v_and_b32 v13, 0xffff0000, v154
    v_fmac_f32 v84, v74, v12
    v_fmac_f32 v85, v74, v13
    v_lshlrev_b32 v12, 16, v155
    v_and_b32 v13, 0xffff0000, v155
    v_fmac_f32 v86, v74, v12
    v_fmac_f32 v87, v74, v13
    s_waitcnt vmcnt(0)
    v_lshlrev_b32 v12, 16, v156
    v_and_b32 v13, 0xffff0000, v156
    v_fmac_f32 v80, v75, v12
    v_fmac_f32 v81, v75, v13
    v_lshlrev_b32 v12, 16, v157
    v_and_b32 v13, 0xffff0000, v157
    v_fmac_f32 v82, v75, v12
    v_fmac_f32 v83, v75, v13
    v_lshlrev_b32 v12, 16, v158
    v_and_b32 v13, 0xffff0000, v158
    v_fmac_f32 v84, v75, v12
    v_fmac_f32 v85, v75, v13
    v_lshlrev_b32 v12, 16, v159
    v_and_b32 v13, 0xffff0000, v159
    v_fmac_f32 v86, v75, v12
    v_fmac_f32 v87, v75, v13
    s_nop 1
    v_add_f32_dpp v80, v80, v80 row_ror:8 row_mask:0xf bank_mask:0xf
    v_add_f32_dpp v81, v81, v81 row_ror:8 row_mask:0xf bank_mask:0xf
    v_add_f32_dpp v82, v82, v82 row_ror:8 row_mask:0xf bank_mask:0xf
    v_add_f32_dpp v83, v83, v83 row_ror:8 row_mask:0xf bank_mask:0xf
    v_add_f32_dpp v84, v84, v84 row_ror:8 row_mask:0xf bank_mask:0xf
    v_add_f32_dpp v85, v85, v85 row_ror:8 row_mask:0xf bank_mask:0xf
    v_add_f32_dpp v86, v86, v86 row_ror:8 row_mask:0xf bank_mask:0xf
    v_add_f32_dpp v87, v87, v87 row_ror:8 row_mask:0xf bank_mask:0xf
    v_lshrrev_b32 v10, 4, v0
    v_lshlrev_b32 v10, 8, v10
    v_and_b32 v11, 7, v0
    v_lshl_add_u32 v10, v11, 5, v10
    v_and_b32 v11, 15, v0
    v_cmp_gt_u32 vcc, 8, v11
    s_and_saveexec_b64 s[58:59], vcc
    ds_write_b128 v10, v[80:83] offset:22528
    ds_write_b128 v10, v[84:87] offset:22544
    s_mov_b64 exec, s[58:59]
    s_waitcnt lgkmcnt(0)
    s_barrier
    s_barrier
    s_cmp_eq_u32 s18, 4
    s_cbranch_scc0 Lcv_end
    v_lshlrev_b32 v10, 2, v2
    ds_read_b32 v60, v10 offset:22528
    ds_read_b32 v61, v10 offset:22784
    ds_read_b32 v62, v10 offset:23040
    ds_read_b32 v63, v10 offset:23296
    ds_read_b32 v64, v10 offset:23552
    ds_read_b32 v65, v10 offset:23808
    ds_read_b32 v66, v10 offset:24064
    ds_read_b32 v67, v10 offset:24320
    ds_read_b32 v68, v10 offset:24576
    ds_read_b32 v69, v10 offset:24832
    ds_read_b32 v70, v10 offset:25088
    ds_read_b32 v71, v10 offset:25344
    ds_read_b32 v72, v10 offset:25600
    ds_read_b32 v73, v10 offset:25856
    ds_read_b32 v74, v10 offset:26112
    ds_read_b32 v75, v10 offset:26368
    s_waitcnt lgkmcnt(0)
    v_add_f32 v60, v60, v61
    v_add_f32 v60, v60, v62
    v_add_f32 v60, v60, v63
    v_add_f32 v60, v60, v64
    v_add_f32 v60, v60, v65
    v_add_f32 v60, v60, v66
    v_add_f32 v60, v60, v67
    v_add_f32 v60, v60, v68
    v_add_f32 v60, v60, v69
    v_add_f32 v60, v60, v70
    v_add_f32 v60, v60, v71
    v_add_f32 v60, v60, v72
    v_add_f32 v60, v60, v73
    v_add_f32 v60, v60, v74
    v_add_f32 v60, v60, v75
    s_mov_b32 s20, s34
    s_mov_b32 s21, s35
    s_mov_b32 s22, 0xc000
    s_mov_b32 s23, 0x00020000
    s_mul_i32 s19, s41, 24576
    s_lshl_b32 s50, s42, 8
    s_add_u32 s19, s19, s50
    buffer_store_dword v60, v10, s[20:23], s19 offen
Lcv_end:
    s_endpgm
.text
.globl ln_kernel
.p2align 8
.type ln_kernel,@function
ln_kernel:
    s_cmp_ge_u32 s2, 256
    s_cbranch_scc1 Lln_end
    s_load_dwordx2 s[24:25], s[0:1], 0
    s_load_dwordx2 s[34:35], s[0:1], 112
    v_lshrrev_b32 v1, 6, v0
    v_and_b32 v2, 63, v0
    v_readfirstlane_b32 s18, v1
    v_lshlrev_b32 v3, 5, v2
    v_lshlrev_b32 v4, 5, v0
    v_lshlrev_b32 v5, 3, v0
    s_cmp_eq_u32 s18, 8
    s_cbranch_scc1 Lln_pf
    s_lshl_b32 s16, s2, 14
    s_lshl_b32 s17, s18, 11
    s_add_u32 s17, s17, s16
    s_waitcnt lgkmcnt(0)
    s_mov_b32 s4, s24
    s_mov_b32 s5, s25
    s_mov_b32 s6, 0x400000
    s_mov_b32 s7, 0x00020000
    s_add_u32 s8, s34, 0x100000
    s_addc_u32 s9, s35, 0
    s_mov_b32 s10, 0x400000
    s_mov_b32 s11, 0x00020000
    s_mov_b32 s12, s34
    s_mov_b32 s13, s35
    s_mov_b32 s14, 0xc000
    s_mov_b32 s15, 0x00020000
    s_add_u32 s20, s34, 0x800000
    s_addc_u32 s21, s35, 0
    s_mov_b32 s22, 0x400000
    s_mov_b32 s23, 0x00020000
    s_add_u32 s28, s34, 0xc00000
    s_addc_u32 s29, s35, 0
    s_mov_b32 s30, 0x400000
    s_mov_b32 s31, 0x00020000
    buffer_load_dwordx4 v[24:27], v4, s[8:11], s16 offen offset:0
    buffer_load_dwordx4 v[28:31], v4, s[8:11], s16 offen offset:16
    s_movk_i32 s19, 0
    buffer_load_dwordx2 v[32:33], v5, s[12:15], s19 offen
    s_add_u32 s19, s19, 24576
    buffer_load_dwordx2 v[42:43], v5, s[12:15], s19 offen
    s_movk_i32 s19, 4096
    buffer_load_dwordx2 v[34:35], v5, s[12:15], s19 offen
    s_add_u32 s19, s19, 24576
    buffer_load_dwordx2 v[44:45], v5, s[12:15], s19 offen
    s_movk_i32 s19, 8192
    buffer_load_dwordx2 v[36:37], v5, s[12:15], s19 offen
    s_add_u32 s19, s19, 24576
    buffer_load_dwordx2 v[46:47], v5, s[12:15], s19 offen
    s_movk_i32 s19, 12288
    buffer_load_dwordx2 v[38:39], v5, s[12:15], s19 offen
    s_add_u32 s19, s19, 24576
    buffer_load_dwordx2 v[48:49], v5, s[12:15], s19 offen
    s_movk_i32 s19, 16384
    buffer_load_dwordx2 v[40:41], v5, s[12:15], s19 offen
    s_add_u32 s19, s19, 24576
    buffer_load_dwordx2 v[50:51], v5, s[12:15], s19 offen
    buffer_load_dwordx4 v[16:19], v3, s[4:7], s17 offen offset:0
    buffer_load_dwordx4 v[20:23], v3, s[4:7], s17 offen offset:16
    v_lshlrev_b32 v6, 2, v0
    s_mov_b32 s40, 0x05040100
    s_mov_b32 s41, 0x07060302
    s_waitcnt vmcnt(12)
    v_perm_b32 v52, v28, v24, s40
    ds_write_b32 v6, v52 offset:0
    v_perm_b32 v53, v28, v24, s41
    ds_write_b32 v6, v53 offset:2064
    v_perm_b32 v54, v29, v25, s40
    ds_write_b32 v6, v54 offset:4128
    v_perm_b32 v55, v29, v25, s41
    ds_write_b32 v6, v55 offset:6192
    v_perm_b32 v56, v30, v26, s40
    ds_write_b32 v6, v56 offset:8256
    v_perm_b32 v57, v30, v26, s41
    ds_write_b32 v6, v57 offset:10320
    v_perm_b32 v58, v31, v27, s40
    ds_write_b32 v6, v58 offset:12384
    v_perm_b32 v59, v31, v27, s41
    ds_write_b32 v6, v59 offset:14448
    s_waitcnt vmcnt(2)
    v_pk_add_f32 v[32:33], v[32:33], v[42:43]
    v_pk_add_f32 v[34:35], v[34:35], v[44:45]
    v_pk_add_f32 v[36:37], v[36:37], v[46:47]
    v_pk_add_f32 v[38:39], v[38:39], v[48:49]
    v_pk_add_f32 v[40:41], v[40:41], v[50:51]
    v_cvt_pk_bf16_f32 v60, v32, v33
    v_lshlrev_b32 v32, 16, v60
    v_and_b32 v33, 0xffff0000, v60
    v_cvt_pk_bf16_f32 v61, v34, v35
    v_lshlrev_b32 v34, 16, v61
    v_and_b32 v35, 0xffff0000, v61
    v_cvt_pk_bf16_f32 v62, v36, v37
    v_lshlrev_b32 v36, 16, v62
    v_and_b32 v37, 0xffff0000, v62
    v_cvt_pk_bf16_f32 v63, v38, v39
    v_lshlrev_b32 v38, 16, v63
    v_and_b32 v39, 0xffff0000, v63
    v_cvt_pk_bf16_f32 v64, v40, v41
    v_lshlrev_b32 v40, 16, v64
    v_and_b32 v41, 0xffff0000, v64
    v_add_f32 v34, 1.0, v34
    v_add_f32 v35, 1.0, v35
    v_cvt_pk_bf16_f32 v61, v34, v35
    v_lshlrev_b32 v34, 16, v61
    v_and_b32 v35, 0xffff0000, v61
    v_add_f32 v40, 1.0, v40
    v_add_f32 v41, 1.0, v41
    v_cvt_pk_bf16_f32 v64, v40, v41
    v_lshlrev_b32 v40, 16, v64
    v_and_b32 v41, 0xffff0000, v64
    ds_write_b64 v5, v[32:33] offset:16512
    ds_write_b64 v5, v[34:35] offset:20608
    ds_write_b64 v5, v[36:37] offset:24704
    ds_write_b64 v5, v[38:39] offset:28800
    ds_write_b64 v5, v[40:41] offset:32896
    s_waitcnt vmcnt(0)
    v_lshlrev_b32 v56, 16, v16
    v_and_b32 v57, 0xffff0000, v16
    v_lshlrev_b32 v58, 16, v17
    v_and_b32 v59, 0xffff0000, v17
    v_lshlrev_b32 v60, 16, v18
    v_and_b32 v61, 0xffff0000, v18
    v_lshlrev_b32 v62, 16, v19
    v_and_b32 v63, 0xffff0000, v19
    v_lshlrev_b32 v64, 16, v20
    v_and_b32 v65, 0xffff0000, v20
    v_lshlrev_b32 v66, 16, v21
    v_and_b32 v67, 0xffff0000, v21
    v_lshlrev_b32 v68, 16, v22
    v_and_b32 v69, 0xffff0000, v22
    v_lshlrev_b32 v70, 16, v23
    v_and_b32 v71, 0xffff0000, v23
    v_pk_add_f32 v[8:9], v[56:57], v[58:59]
    v_pk_add_f32 v[10:11], v[60:61], v[62:63]
    v_pk_add_f32 v[12:13], v[64:65], v[66:67]
    v_pk_add_f32 v[14:15], v[68:69], v[70:71]
    v_pk_add_f32 v[8:9], v[8:9], v[10:11]
    v_pk_add_f32 v[12:13], v[12:13], v[14:15]
    v_pk_add_f32 v[8:9], v[8:9], v[12:13]
    v_add_f32 v8, v8, v9
    s_nop 1
    v_add_f32_dpp v8, v8, v8 row_ror:1 row_mask:0xf bank_mask:0xf
    s_nop 1
    v_add_f32_dpp v8, v8, v8 row_ror:2 row_mask:0xf bank_mask:0xf
    s_nop 1
    v_add_f32_dpp v8, v8, v8 row_ror:4 row_mask:0xf bank_mask:0xf
    s_nop 1
    v_add_f32_dpp v8, v8, v8 row_ror:8 row_mask:0xf bank_mask:0xf
    s_nop 1
    v_add_f32_dpp v8, v8, v8 row_bcast:15 row_mask:0xa bank_mask:0xf
    s_nop 1
    v_add_f32_dpp v8, v8, v8 row_bcast:31 row_mask:0xc bank_mask:0xf
    s_nop 0
    v_readlane_b32 s44, v8, 63
    s_nop 1
    v_mov_b32 v9, 0x3a800000
    v_mul_f32 v10, s44, v9
    v_mov_b32 v11, v10
    v_pk_add_f32 v[72:73], v[56:57], v[10:11] neg_lo:[0,1] neg_hi:[0,1]
    v_pk_add_f32 v[74:75], v[58:59], v[10:11] neg_lo:[0,1] neg_hi:[0,1]
    v_pk_add_f32 v[76:77], v[60:61], v[10:11] neg_lo:[0,1] neg_hi:[0,1]
    v_pk_add_f32 v[78:79], v[62:63], v[10:11] neg_lo:[0,1] neg_hi:[0,1]
    v_pk_add_f32 v[80:81], v[64:65], v[10:11] neg_lo:[0,1] neg_hi:[0,1]
    v_pk_add_f32 v[82:83], v[66:67], v[10:11] neg_lo:[0,1] neg_hi:[0,1]
    v_pk_add_f32 v[84:85], v[68:69], v[10:11] neg_lo:[0,1] neg_hi:[0,1]
    v_pk_add_f32 v[86:87], v[70:71], v[10:11] neg_lo:[0,1] neg_hi:[0,1]
    v_pk_mul_f32 v[12:13], v[72:73], v[72:73]
    v_pk_mul_f32 v[14:15], v[74:75], v[74:75]
    v_pk_fma_f32 v[12:13], v[76:77], v[76:77], v[12:13]
    v_pk_fma_f32 v[14:15], v[78:79], v[78:79], v[14:15]
    v_pk_fma_f32 v[12:13], v[80:81], v[80:81], v[12:13]
    v_pk_fma_f32 v[14:15], v[82:83], v[82:83], v[14:15]
    v_pk_fma_f32 v[12:13], v[84:85], v[84:85], v[12:13]
    v_pk_fma_f32 v[14:15], v[86:87], v[86:87], v[14:15]
    v_pk_add_f32 v[12:13], v[12:13], v[14:15]
    v_add_f32 v12, v12, v13
    s_nop 1
    v_add_f32_dpp v12, v12, v12 row_ror:1 row_mask:0xf bank_mask:0xf
    s_nop 1
    v_add_f32_dpp v12, v12, v12 row_ror:2 row_mask:0xf bank_mask:0xf
    s_nop 1
    v_add_f32_dpp v12, v12, v12 row_ror:4 row_mask:0xf bank_mask:0xf
    s_nop 1
    v_add_f32_dpp v12, v12, v12 row_ror:8 row_mask:0xf bank_mask:0xf
    s_nop 1
    v_add_f32_dpp v12, v12, v12 row_bcast:15 row_mask:0xa bank_mask:0xf
    s_nop 1
    v_add_f32_dpp v12, v12, v12 row_bcast:31 row_mask:0xc bank_mask:0xf
    s_nop 0
    v_readlane_b32 s44, v12, 63
    s_nop 1
    v_mul_f32 v12, s44, v9
    v_cvt_pk_bf16_f32 v13, v12, v10
    v_lshlrev_b32 v12, 16, v13
    v_and_b32 v10, 0xffff0000, v13
    v_add_f32 v12, 0x3727c5ac, v12
    v_cvt_pk_bf16_f32 v14, v12, v13
    v_lshlrev_b32 v12, 16, v14
    v_and_b32 v13, 0xffff0000, v14
    v_sqrt_f32 v12, v12
    s_nop 0
    v_cvt_pk_bf16_f32 v14, v12, v13
    v_lshlrev_b32 v12, 16, v14
    v_and_b32 v13, 0xffff0000, v14
    v_rcp_f32 v12, v12
    v_mov_b32 v11, v10
    v_mov_b32 v13, v12
    s_waitcnt lgkmcnt(0)
    s_barrier
    s_mul_i32 s19, s18, 2064
    v_add_u32 v6, s19, v3
    v_lshlrev_b32 v7, 6, v2
    ds_read_b128 v[104:107], v7 offset:20608
    ds_read_b128 v[108:111], v7 offset:20624
    ds_read_b128 v[112:115], v7 offset:20640
    ds_read_b128 v[116:119], v7 offset:20656
    ds_read_b128 v[88:91], v7 offset:16512
    ds_read_b128 v[92:95], v7 offset:16528
    ds_read_b128 v[96:99], v7 offset:16544
    ds_read_b128 v[100:103], v7 offset:16560
    ds_read_b128 v[24:27], v6 offset:0
    ds_read_b128 v[28:31], v6 offset:16
    ds_read_b128 v[120:123], v7 offset:24704
    ds_read_b128 v[124:127], v7 offset:24720
    ds_read_b128 v[128:131], v7 offset:24736
    ds_read_b128 v[132:135], v7 offset:24752
    ds_read_b128 v[152:155], v7 offset:32896
    ds_read_b128 v[156:159], v7 offset:32912
    ds_read_b128 v[160:163], v7 offset:32928
    ds_read_b128 v[164:167], v7 offset:32944
    ds_read_b128 v[136:139], v7 offset:28800
    ds_read_b128 v[140:143], v7 offset:28816
    ds_read_b128 v[144:147], v7 offset:28832
    ds_read_b128 v[148:151], v7 offset:28848
    s_waitcnt lgkmcnt(14)
    v_pk_add_f32 v[72:73], v[56:57], v[10:11] neg_lo:[0,1] neg_hi:[0,1]
    v_cvt_pk_bf16_f32 v8, v72, v73
    v_lshlrev_b32 v72, 16, v8
    v_and_b32 v73, 0xffff0000, v8
    v_pk_mul_f32 v[72:73], v[72:73], v[12:13]
    v_cvt_pk_bf16_f32 v8, v72, v73
    v_lshlrev_b32 v72, 16, v8
    v_and_b32 v73, 0xffff0000, v8
    v_pk_mul_f32 v[72:73], v[72:73], v[104:105]
    v_cvt_pk_bf16_f32 v8, v72, v73
    v_lshlrev_b32 v72, 16, v8
    v_and_b32 v73, 0xffff0000, v8
    v_pk_add_f32 v[72:73], v[72:73], v[88:89]
    v_cvt_pk_bf16_f32 v8, v72, v73
    v_lshlrev_b32 v72, 16, v8
    v_and_b32 v73, 0xffff0000, v8
    v_pk_add_f32 v[74:75], v[58:59], v[10:11] neg_lo:[0,1] neg_hi:[0,1]
    v_cvt_pk_bf16_f32 v8, v74, v75
    v_lshlrev_b32 v74, 16, v8
    v_and_b32 v75, 0xffff0000, v8
    v_pk_mul_f32 v[74:75], v[74:75], v[12:13]
    v_cvt_pk_bf16_f32 v8, v74, v75
    v_lshlrev_b32 v74, 16, v8
    v_and_b32 v75, 0xffff0000, v8
    v_pk_mul_f32 v[74:75], v[74:75], v[106:107]
    v_cvt_pk_bf16_f32 v8, v74, v75
    v_lshlrev_b32 v74, 16, v8
    v_and_b32 v75, 0xffff0000, v8
    v_pk_add_f32 v[74:75], v[74:75], v[90:91]
    v_cvt_pk_bf16_f32 v8, v74, v75
    v_lshlrev_b32 v74, 16, v8
    v_and_b32 v75, 0xffff0000, v8
    v_pk_add_f32 v[76:77], v[60:61], v[10:11] neg_lo:[0,1] neg_hi:[0,1]
    v_cvt_pk_bf16_f32 v8, v76, v77
    v_lshlrev_b32 v76, 16, v8
    v_and_b32 v77, 0xffff0000, v8
    v_pk_mul_f32 v[76:77], v[76:77], v[12:13]
    v_cvt_pk_bf16_f32 v8, v76, v77
    v_lshlrev_b32 v76, 16, v8
    v_and_b32 v77, 0xffff0000, v8
    v_pk_mul_f32 v[76:77], v[76:77], v[108:109]
    v_cvt_pk_bf16_f32 v8, v76, v77
    v_lshlrev_b32 v76, 16, v8
    v_and_b32 v77, 0xffff0000, v8
    v_pk_add_f32 v[76:77], v[76:77], v[92:93]
    v_cvt_pk_bf16_f32 v8, v76, v77
    v_lshlrev_b32 v76, 16, v8
    v_and_b32 v77, 0xffff0000, v8
    v_pk_add_f32 v[78:79], v[62:63], v[10:11] neg_lo:[0,1] neg_hi:[0,1]
    v_cvt_pk_bf16_f32 v8, v78, v79
    v_lshlrev_b32 v78, 16, v8
    v_and_b32 v79, 0xffff0000, v8
    v_pk_mul_f32 v[78:79], v[78:79], v[12:13]
    v_cvt_pk_bf16_f32 v8, v78, v79
    v_lshlrev_b32 v78, 16, v8
    v_and_b32 v79, 0xffff0000, v8
    v_pk_mul_f32 v[78:79], v[78:79], v[110:111]
    v_cvt_pk_bf16_f32 v8, v78, v79
    v_lshlrev_b32 v78, 16, v8
    v_and_b32 v79, 0xffff0000, v8
    v_pk_add_f32 v[78:79], v[78:79], v[94:95]
    v_cvt_pk_bf16_f32 v8, v78, v79
    v_lshlrev_b32 v78, 16, v8
    v_and_b32 v79, 0xffff0000, v8
    v_pk_add_f32 v[80:81], v[64:65], v[10:11] neg_lo:[0,1] neg_hi:[0,1]
    v_cvt_pk_bf16_f32 v8, v80, v81
    v_lshlrev_b32 v80, 16, v8
    v_and_b32 v81, 0xffff0000, v8
    v_pk_mul_f32 v[80:81], v[80:81], v[12:13]
    v_cvt_pk_bf16_f32 v8, v80, v81
    v_lshlrev_b32 v80, 16, v8
    v_and_b32 v81, 0xffff0000, v8
    v_pk_mul_f32 v[80:81], v[80:81], v[112:113]
    v_cvt_pk_bf16_f32 v8, v80, v81
    v_lshlrev_b32 v80, 16, v8
    v_and_b32 v81, 0xffff0000, v8
    v_pk_add_f32 v[80:81], v[80:81], v[96:97]
    v_cvt_pk_bf16_f32 v8, v80, v81
    v_lshlrev_b32 v80, 16, v8
    v_and_b32 v81, 0xffff0000, v8
    v_pk_add_f32 v[82:83], v[66:67], v[10:11] neg_lo:[0,1] neg_hi:[0,1]
    v_cvt_pk_bf16_f32 v8, v82, v83
    v_lshlrev_b32 v82, 16, v8
    v_and_b32 v83, 0xffff0000, v8
    v_pk_mul_f32 v[82:83], v[82:83], v[12:13]
    v_cvt_pk_bf16_f32 v8, v82, v83
    v_lshlrev_b32 v82, 16, v8
    v_and_b32 v83, 0xffff0000, v8
    v_pk_mul_f32 v[82:83], v[82:83], v[114:115]
    v_cvt_pk_bf16_f32 v8, v82, v83
    v_lshlrev_b32 v82, 16, v8
    v_and_b32 v83, 0xffff0000, v8
    v_pk_add_f32 v[82:83], v[82:83], v[98:99]
    v_cvt_pk_bf16_f32 v8, v82, v83
    v_lshlrev_b32 v82, 16, v8
    v_and_b32 v83, 0xffff0000, v8
    v_pk_add_f32 v[84:85], v[68:69], v[10:11] neg_lo:[0,1] neg_hi:[0,1]
    v_cvt_pk_bf16_f32 v8, v84, v85
    v_lshlrev_b32 v84, 16, v8
    v_and_b32 v85, 0xffff0000, v8
    v_pk_mul_f32 v[84:85], v[84:85], v[12:13]
    v_cvt_pk_bf16_f32 v8, v84, v85
    v_lshlrev_b32 v84, 16, v8
    v_and_b32 v85, 0xffff0000, v8
    v_pk_mul_f32 v[84:85], v[84:85], v[116:117]
    v_cvt_pk_bf16_f32 v8, v84, v85
    v_lshlrev_b32 v84, 16, v8
    v_and_b32 v85, 0xffff0000, v8
    v_pk_add_f32 v[84:85], v[84:85], v[100:101]
    v_cvt_pk_bf16_f32 v8, v84, v85
    v_lshlrev_b32 v84, 16, v8
    v_and_b32 v85, 0xffff0000, v8
    v_pk_add_f32 v[86:87], v[70:71], v[10:11] neg_lo:[0,1] neg_hi:[0,1]
    v_cvt_pk_bf16_f32 v8, v86, v87
    v_lshlrev_b32 v86, 16, v8
    v_and_b32 v87, 0xffff0000, v8
    v_pk_mul_f32 v[86:87], v[86:87], v[12:13]
    v_cvt_pk_bf16_f32 v8, v86, v87
    v_lshlrev_b32 v86, 16, v8
    v_and_b32 v87, 0xffff0000, v8
    v_pk_mul_f32 v[86:87], v[86:87], v[118:119]
    v_cvt_pk_bf16_f32 v8, v86, v87
    v_lshlrev_b32 v86, 16, v8
    v_and_b32 v87, 0xffff0000, v8
    v_pk_add_f32 v[86:87], v[86:87], v[102:103]
    v_cvt_pk_bf16_f32 v8, v86, v87
    v_lshlrev_b32 v86, 16, v8
    v_and_b32 v87, 0xffff0000, v8
    s_waitcnt lgkmcnt(8)
    v_lshlrev_b32 v10, 16, v24
    v_and_b32 v11, 0xffff0000, v24
    v_pk_mul_f32 v[72:73], v[72:73], v[10:11]
    v_cvt_pk_bf16_f32 v8, v72, v73
    v_lshlrev_b32 v72, 16, v8
    v_and_b32 v73, 0xffff0000, v8
    v_pk_mul_f32 v[72:73], v[72:73], v[120:121]
    v_cvt_pk_bf16_f32 v8, v72, v73
    v_lshlrev_b32 v72, 16, v8
    v_and_b32 v73, 0xffff0000, v8
    v_pk_add_f32 v[56:57], v[56:57], v[72:73]
    v_cvt_pk_bf16_f32 v16, v56, v57
    v_lshlrev_b32 v56, 16, v16
    v_and_b32 v57, 0xffff0000, v16
    v_lshlrev_b32 v10, 16, v25
    v_and_b32 v11, 0xffff0000, v25
    v_pk_mul_f32 v[74:75], v[74:75], v[10:11]
    v_cvt_pk_bf16_f32 v8, v74, v75
    v_lshlrev_b32 v74, 16, v8
    v_and_b32 v75, 0xffff0000, v8
    v_pk_mul_f32 v[74:75], v[74:75], v[122:123]
    v_cvt_pk_bf16_f32 v8, v74, v75
    v_lshlrev_b32 v74, 16, v8
    v_and_b32 v75, 0xffff0000, v8
    v_pk_add_f32 v[58:59], v[58:59], v[74:75]
    v_cvt_pk_bf16_f32 v17, v58, v59
    v_lshlrev_b32 v58, 16, v17
    v_and_b32 v59, 0xffff0000, v17
    v_lshlrev_b32 v10, 16, v26
    v_and_b32 v11, 0xffff0000, v26
    v_pk_mul_f32 v[76:77], v[76:77], v[10:11]
    v_cvt_pk_bf16_f32 v8, v76, v77
    v_lshlrev_b32 v76, 16, v8
    v_and_b32 v77, 0xffff0000, v8
    v_pk_mul_f32 v[76:77], v[76:77], v[124:125]
    v_cvt_pk_bf16_f32 v8, v76, v77
    v_lshlrev_b32 v76, 16, v8
    v_and_b32 v77, 0xffff0000, v8
    v_pk_add_f32 v[60:61], v[60:61], v[76:77]
    v_cvt_pk_bf16_f32 v18, v60, v61
    v_lshlrev_b32 v60, 16, v18
    v_and_b32 v61, 0xffff0000, v18
    v_lshlrev_b32 v10, 16, v27
    v_and_b32 v11, 0xffff0000, v27
    v_pk_mul_f32 v[78:79], v[78:79], v[10:11]
    v_cvt_pk_bf16_f32 v8, v78, v79
    v_lshlrev_b32 v78, 16, v8
    v_and_b32 v79, 0xffff0000, v8
    v_pk_mul_f32 v[78:79], v[78:79], v[126:127]
    v_cvt_pk_bf16_f32 v8, v78, v79
    v_lshlrev_b32 v78, 16, v8
    v_and_b32 v79, 0xffff0000, v8
    v_pk_add_f32 v[62:63], v[62:63], v[78:79]
    v_cvt_pk_bf16_f32 v19, v62, v63
    v_lshlrev_b32 v62, 16, v19
    v_and_b32 v63, 0xffff0000, v19
    v_lshlrev_b32 v10, 16, v28
    v_and_b32 v11, 0xffff0000, v28
    v_pk_mul_f32 v[80:81], v[80:81], v[10:11]
    v_cvt_pk_bf16_f32 v8, v80, v81
    v_lshlrev_b32 v80, 16, v8
    v_and_b32 v81, 0xffff0000, v8
    v_pk_mul_f32 v[80:81], v[80:81], v[128:129]
    v_cvt_pk_bf16_f32 v8, v80, v81
    v_lshlrev_b32 v80, 16, v8
    v_and_b32 v81, 0xffff0000, v8
    v_pk_add_f32 v[64:65], v[64:65], v[80:81]
    v_cvt_pk_bf16_f32 v20, v64, v65
    v_lshlrev_b32 v64, 16, v20
    v_and_b32 v65, 0xffff0000, v20
    v_lshlrev_b32 v10, 16, v29
    v_and_b32 v11, 0xffff0000, v29
    v_pk_mul_f32 v[82:83], v[82:83], v[10:11]
    v_cvt_pk_bf16_f32 v8, v82, v83
    v_lshlrev_b32 v82, 16, v8
    v_and_b32 v83, 0xffff0000, v8
    v_pk_mul_f32 v[82:83], v[82:83], v[130:131]
    v_cvt_pk_bf16_f32 v8, v82, v83
    v_lshlrev_b32 v82, 16, v8
    v_and_b32 v83, 0xffff0000, v8
    v_pk_add_f32 v[66:67], v[66:67], v[82:83]
    v_cvt_pk_bf16_f32 v21, v66, v67
    v_lshlrev_b32 v66, 16, v21
    v_and_b32 v67, 0xffff0000, v21
    v_lshlrev_b32 v10, 16, v30
    v_and_b32 v11, 0xffff0000, v30
    v_pk_mul_f32 v[84:85], v[84:85], v[10:11]
    v_cvt_pk_bf16_f32 v8, v84, v85
    v_lshlrev_b32 v84, 16, v8
    v_and_b32 v85, 0xffff0000, v8
    v_pk_mul_f32 v[84:85], v[84:85], v[132:133]
    v_cvt_pk_bf16_f32 v8, v84, v85
    v_lshlrev_b32 v84, 16, v8
    v_and_b32 v85, 0xffff0000, v8
    v_pk_add_f32 v[68:69], v[68:69], v[84:85]
    v_cvt_pk_bf16_f32 v22, v68, v69
    v_lshlrev_b32 v68, 16, v22
    v_and_b32 v69, 0xffff0000, v22
    v_lshlrev_b32 v10, 16, v31
    v_and_b32 v11, 0xffff0000, v31
    v_pk_mul_f32 v[86:87], v[86:87], v[10:11]
    v_cvt_pk_bf16_f32 v8, v86, v87
    v_lshlrev_b32 v86, 16, v8
    v_and_b32 v87, 0xffff0000, v8
    v_pk_mul_f32 v[86:87], v[86:87], v[134:135]
    v_cvt_pk_bf16_f32 v8, v86, v87
    v_lshlrev_b32 v86, 16, v8
    v_and_b32 v87, 0xffff0000, v8
    v_pk_add_f32 v[70:71], v[70:71], v[86:87]
    v_cvt_pk_bf16_f32 v23, v70, v71
    v_lshlrev_b32 v70, 16, v23
    v_and_b32 v71, 0xffff0000, v23
    buffer_store_dwordx4 v[16:19], v3, s[20:23], s17 offen offset:0
    buffer_store_dwordx4 v[20:23], v3, s[20:23], s17 offen offset:16
    v_pk_add_f32 v[8:9], v[56:57], v[58:59]
    v_pk_add_f32 v[10:11], v[60:61], v[62:63]
    v_pk_add_f32 v[12:13], v[64:65], v[66:67]
    v_pk_add_f32 v[14:15], v[68:69], v[70:71]
    v_pk_add_f32 v[8:9], v[8:9], v[10:11]
    v_pk_add_f32 v[12:13], v[12:13], v[14:15]
    v_pk_add_f32 v[8:9], v[8:9], v[12:13]
    v_add_f32 v8, v8, v9
    s_nop 1
    v_add_f32_dpp v8, v8, v8 row_ror:1 row_mask:0xf bank_mask:0xf
    s_nop 1
    v_add_f32_dpp v8, v8, v8 row_ror:2 row_mask:0xf bank_mask:0xf
    s_nop 1
    v_add_f32_dpp v8, v8, v8 row_ror:4 row_mask:0xf bank_mask:0xf
    s_nop 1
    v_add_f32_dpp v8, v8, v8 row_ror:8 row_mask:0xf bank_mask:0xf
    s_nop 1
    v_add_f32_dpp v8, v8, v8 row_bcast:15 row_mask:0xa bank_mask:0xf
    s_nop 1
    v_add_f32_dpp v8, v8, v8 row_bcast:31 row_mask:0xc bank_mask:0xf
    s_nop 0
    v_readlane_b32 s44, v8, 63
    s_nop 1
    v_mov_b32 v9, 0x3a800000
    v_mul_f32 v10, s44, v9
    v_mov_b32 v11, v10
    v_pk_add_f32 v[72:73], v[56:57], v[10:11] neg_lo:[0,1] neg_hi:[0,1]
    v_pk_add_f32 v[74:75], v[58:59], v[10:11] neg_lo:[0,1] neg_hi:[0,1]
    v_pk_add_f32 v[76:77], v[60:61], v[10:11] neg_lo:[0,1] neg_hi:[0,1]
    v_pk_add_f32 v[78:79], v[62:63], v[10:11] neg_lo:[0,1] neg_hi:[0,1]
    v_pk_add_f32 v[80:81], v[64:65], v[10:11] neg_lo:[0,1] neg_hi:[0,1]
    v_pk_add_f32 v[82:83], v[66:67], v[10:11] neg_lo:[0,1] neg_hi:[0,1]
    v_pk_add_f32 v[84:85], v[68:69], v[10:11] neg_lo:[0,1] neg_hi:[0,1]
    v_pk_add_f32 v[86:87], v[70:71], v[10:11] neg_lo:[0,1] neg_hi:[0,1]
    v_pk_mul_f32 v[12:13], v[72:73], v[72:73]
    v_pk_mul_f32 v[14:15], v[74:75], v[74:75]
    v_pk_fma_f32 v[12:13], v[76:77], v[76:77], v[12:13]
    v_pk_fma_f32 v[14:15], v[78:79], v[78:79], v[14:15]
    v_pk_fma_f32 v[12:13], v[80:81], v[80:81], v[12:13]
    v_pk_fma_f32 v[14:15], v[82:83], v[82:83], v[14:15]
    v_pk_fma_f32 v[12:13], v[84:85], v[84:85], v[12:13]
    v_pk_fma_f32 v[14:15], v[86:87], v[86:87], v[14:15]
    v_pk_add_f32 v[12:13], v[12:13], v[14:15]
    v_add_f32 v12, v12, v13
    s_nop 1
    v_add_f32_dpp v12, v12, v12 row_ror:1 row_mask:0xf bank_mask:0xf
    s_nop 1
    v_add_f32_dpp v12, v12, v12 row_ror:2 row_mask:0xf bank_mask:0xf
    s_nop 1
    v_add_f32_dpp v12, v12, v12 row_ror:4 row_mask:0xf bank_mask:0xf
    s_nop 1
    v_add_f32_dpp v12, v12, v12 row_ror:8 row_mask:0xf bank_mask:0xf
    s_nop 1
    v_add_f32_dpp v12, v12, v12 row_bcast:15 row_mask:0xa bank_mask:0xf
    s_nop 1
    v_add_f32_dpp v12, v12, v12 row_bcast:31 row_mask:0xc bank_mask:0xf
    s_nop 0
    v_readlane_b32 s44, v12, 63
    s_nop 1
    v_mul_f32 v12, s44, v9
    v_cvt_pk_bf16_f32 v13, v12, v10
    v_lshlrev_b32 v12, 16, v13
    v_and_b32 v10, 0xffff0000, v13
    v_add_f32 v12, 0x3727c5ac, v12
    v_cvt_pk_bf16_f32 v14, v12, v13
    v_lshlrev_b32 v12, 16, v14
    v_and_b32 v13, 0xffff0000, v14
    v_sqrt_f32 v12, v12
    s_nop 0
    v_cvt_pk_bf16_f32 v14, v12, v13
    v_lshlrev_b32 v12, 16, v14
    v_and_b32 v13, 0xffff0000, v14
    v_rcp_f32 v12, v12
    v_mov_b32 v11, v10
    v_mov_b32 v13, v12
    s_waitcnt lgkmcnt(0)
    v_pk_add_f32 v[72:73], v[56:57], v[10:11] neg_lo:[0,1] neg_hi:[0,1]
    v_cvt_pk_bf16_f32 v8, v72, v73
    v_lshlrev_b32 v72, 16, v8
    v_and_b32 v73, 0xffff0000, v8
    v_pk_mul_f32 v[72:73], v[72:73], v[12:13]
    v_cvt_pk_bf16_f32 v8, v72, v73
    v_lshlrev_b32 v72, 16, v8
    v_and_b32 v73, 0xffff0000, v8
    v_pk_mul_f32 v[72:73], v[72:73], v[152:153]
    v_cvt_pk_bf16_f32 v8, v72, v73
    v_lshlrev_b32 v72, 16, v8
    v_and_b32 v73, 0xffff0000, v8
    v_pk_add_f32 v[72:73], v[72:73], v[136:137]
    v_cvt_pk_bf16_f32 v24, v72, v73
    v_pk_add_f32 v[74:75], v[58:59], v[10:11] neg_lo:[0,1] neg_hi:[0,1]
    v_cvt_pk_bf16_f32 v8, v74, v75
    v_lshlrev_b32 v74, 16, v8
    v_and_b32 v75, 0xffff0000, v8
    v_pk_mul_f32 v[74:75], v[74:75], v[12:13]
    v_cvt_pk_bf16_f32 v8, v74, v75
    v_lshlrev_b32 v74, 16, v8
    v_and_b32 v75, 0xffff0000, v8
    v_pk_mul_f32 v[74:75], v[74:75], v[154:155]
    v_cvt_pk_bf16_f32 v8, v74, v75
    v_lshlrev_b32 v74, 16, v8
    v_and_b32 v75, 0xffff0000, v8
    v_pk_add_f32 v[74:75], v[74:75], v[138:139]
    v_cvt_pk_bf16_f32 v25, v74, v75
    v_pk_add_f32 v[76:77], v[60:61], v[10:11] neg_lo:[0,1] neg_hi:[0,1]
    v_cvt_pk_bf16_f32 v8, v76, v77
    v_lshlrev_b32 v76, 16, v8
    v_and_b32 v77, 0xffff0000, v8
    v_pk_mul_f32 v[76:77], v[76:77], v[12:13]
    v_cvt_pk_bf16_f32 v8, v76, v77
    v_lshlrev_b32 v76, 16, v8
    v_and_b32 v77, 0xffff0000, v8
    v_pk_mul_f32 v[76:77], v[76:77], v[156:157]
    v_cvt_pk_bf16_f32 v8, v76, v77
    v_lshlrev_b32 v76, 16, v8
    v_and_b32 v77, 0xffff0000, v8
    v_pk_add_f32 v[76:77], v[76:77], v[140:141]
    v_cvt_pk_bf16_f32 v26, v76, v77
    v_pk_add_f32 v[78:79], v[62:63], v[10:11] neg_lo:[0,1] neg_hi:[0,1]
    v_cvt_pk_bf16_f32 v8, v78, v79
    v_lshlrev_b32 v78, 16, v8
    v_and_b32 v79, 0xffff0000, v8
    v_pk_mul_f32 v[78:79], v[78:79], v[12:13]
    v_cvt_pk_bf16_f32 v8, v78, v79
    v_lshlrev_b32 v78, 16, v8
    v_and_b32 v79, 0xffff0000, v8
    v_pk_mul_f32 v[78:79], v[78:79], v[158:159]
    v_cvt_pk_bf16_f32 v8, v78, v79
    v_lshlrev_b32 v78, 16, v8
    v_and_b32 v79, 0xffff0000, v8
    v_pk_add_f32 v[78:79], v[78:79], v[142:143]
    v_cvt_pk_bf16_f32 v27, v78, v79
    v_pk_add_f32 v[80:81], v[64:65], v[10:11] neg_lo:[0,1] neg_hi:[0,1]
    v_cvt_pk_bf16_f32 v8, v80, v81
    v_lshlrev_b32 v80, 16, v8
    v_and_b32 v81, 0xffff0000, v8
    v_pk_mul_f32 v[80:81], v[80:81], v[12:13]
    v_cvt_pk_bf16_f32 v8, v80, v81
    v_lshlrev_b32 v80, 16, v8
    v_and_b32 v81, 0xffff0000, v8
    v_pk_mul_f32 v[80:81], v[80:81], v[160:161]
    v_cvt_pk_bf16_f32 v8, v80, v81
    v_lshlrev_b32 v80, 16, v8
    v_and_b32 v81, 0xffff0000, v8
    v_pk_add_f32 v[80:81], v[80:81], v[144:145]
    v_cvt_pk_bf16_f32 v28, v80, v81
    v_pk_add_f32 v[82:83], v[66:67], v[10:11] neg_lo:[0,1] neg_hi:[0,1]
    v_cvt_pk_bf16_f32 v8, v82, v83
    v_lshlrev_b32 v82, 16, v8
    v_and_b32 v83, 0xffff0000, v8
    v_pk_mul_f32 v[82:83], v[82:83], v[12:13]
    v_cvt_pk_bf16_f32 v8, v82, v83
    v_lshlrev_b32 v82, 16, v8
    v_and_b32 v83, 0xffff0000, v8
    v_pk_mul_f32 v[82:83], v[82:83], v[162:163]
    v_cvt_pk_bf16_f32 v8, v82, v83
    v_lshlrev_b32 v82, 16, v8
    v_and_b32 v83, 0xffff0000, v8
    v_pk_add_f32 v[82:83], v[82:83], v[146:147]
    v_cvt_pk_bf16_f32 v29, v82, v83
    v_pk_add_f32 v[84:85], v[68:69], v[10:11] neg_lo:[0,1] neg_hi:[0,1]
    v_cvt_pk_bf16_f32 v8, v84, v85
    v_lshlrev_b32 v84, 16, v8
    v_and_b32 v85, 0xffff0000, v8
    v_pk_mul_f32 v[84:85], v[84:85], v[12:13]
    v_cvt_pk_bf16_f32 v8, v84, v85
    v_lshlrev_b32 v84, 16, v8
    v_and_b32 v85, 0xffff0000, v8
    v_pk_mul_f32 v[84:85], v[84:85], v[164:165]
    v_cvt_pk_bf16_f32 v8, v84, v85
    v_lshlrev_b32 v84, 16, v8
    v_and_b32 v85, 0xffff0000, v8
    v_pk_add_f32 v[84:85], v[84:85], v[148:149]
    v_cvt_pk_bf16_f32 v30, v84, v85
    v_pk_add_f32 v[86:87], v[70:71], v[10:11] neg_lo:[0,1] neg_hi:[0,1]
    v_cvt_pk_bf16_f32 v8, v86, v87
    v_lshlrev_b32 v86, 16, v8
    v_and_b32 v87, 0xffff0000, v8
    v_pk_mul_f32 v[86:87], v[86:87], v[12:13]
    v_cvt_pk_bf16_f32 v8, v86, v87
    v_lshlrev_b32 v86, 16, v8
    v_and_b32 v87, 0xffff0000, v8
    v_pk_mul_f32 v[86:87], v[86:87], v[166:167]
    v_cvt_pk_bf16_f32 v8, v86, v87
    v_lshlrev_b32 v86, 16, v8
    v_and_b32 v87, 0xffff0000, v8
    v_pk_add_f32 v[86:87], v[86:87], v[150:151]
    v_cvt_pk_bf16_f32 v31, v86, v87
    buffer_store_dwordx4 v[24:27], v3, s[28:31], s17 offen offset:0
    buffer_store_dwordx4 v[28:31], v3, s[28:31], s17 offen offset:16
    s_endpgm
Lln_pf:
    s_load_dwordx4 s[44:47], s[0:1], 56
    s_waitcnt lgkmcnt(0)
    s_add_u32 s36, s34, 0x10000
    s_addc_u32 s37, s35, 0
    s_mov_b32 s38, 0x4000
    s_mov_b32 s39, 0x00020000
    s_mov_b32 s48, s44
    s_mov_b32 s49, s45
    s_mov_b32 s50, 0x700000
    s_mov_b32 s51, 0x00020000
    s_mov_b32 s52, s46
    s_mov_b32 s53, s47
    s_mov_b32 s54, 0x700000
    s_mov_b32 s55, 0x00020000
    v_mov_b32 v6, 0
    v_lshlrev_b32 v7, 10, v2
    s_lshl_b32 s19, s2, 7
    v_cmp_eq_u32 vcc, 0, v2
    s_and_saveexec_b64 s[40:41], vcc
    buffer_store_dword v6, v7, s[36:39], s19 offen
    s_mov_b64 exec, s[40:41]
    v_mul_u32_u24 v10, 9363, v2
    v_lshrrev_b32 v10, 16, v10
    v_mul_u32_u24 v11, 7, v10
    v_sub_u32 v11, v2, v11
    s_movk_i32 s19, 7168
    v_mul_lo_u32 v10, v10, s19
    v_lshl_add_u32 v10, v11, 7, v10
    v_cmp_gt_u32 vcc, 56, v2
    v_mov_b32 v11, 0x80000000
    s_nop 1
    v_cndmask_b32 v10, v11, v10, vcc
    s_and_b32 s43, s2, 7
    s_mul_i32 s43, s43, 896
    s_lshr_b32 s42, s2, 3
    s_mul_i32 s42, s42, 57344
    s_add_u32 s43, s43, s42
    s_barrier
    buffer_load_dword v20, v10, s[48:51], s43 offen
    buffer_load_dword v21, v10, s[52:55], s43 offen
    s_add_u32 s43, s43, 1835008
Lln_end:
    s_endpgm
.text
.globl gemm1_kernel
.p2align 8
.type gemm1_kernel,@function
gemm1_kernel:
    s_cmp_ge_u32 s2, 256
    s_cbranch_scc1 Lg1_end
    s_load_dwordx4 s[24:27], s[0:1], 56
    s_load_dwordx2 s[28:29], s[0:1], 112
    s_load_dwordx2 s[44:45], s[0:1], 72
    v_lshrrev_b32 v1, 6, v0
    v_and_b32 v2, 63, v0
    v_readfirstlane_b32 s18, v1
    s_and_b32 s16, s2, 7
    s_lshl_b32 s16, s16, 2
    s_lshr_b32 s17, s2, 3
    s_and_b32 s17, s17, 3
    s_add_u32 s16, s16, s17
    s_lshr_b32 s17, s2, 5
    s_and_b32 s19, s18, 3
    s_lshr_b32 s20, s18, 2
    v_lshrrev_b32 v20, 4, v2
    v_and_b32 v21, 15, v2
    v_lshrrev_b32 v22, 3, v2
    v_and_b32 v23, 7, v2
    v_xor_b32 v24, v23, v20
    v_lshlrev_b32 v24, 4, v24
    v_lshl_add_u32 v4, v22, 11, v24
    v_xor_b32 v5, 64, v4
    v_lshrrev_b32 v24, 1, v21
    v_and_b32 v25, 1, v21
    s_movk_i32 s21, 7168
    v_mul_lo_u32 v26, v20, s21
    v_lshl_add_u32 v26, v25, 4, v26
    v_mov_b32 v28, 0x80000000
    v_xor_b32 v27, v24, v20
    v_cmp_ne_u32 vcc, 7, v27
    v_lshl_add_u32 v27, v27, 5, v26
    s_nop 1
    v_cndmask_b32 v6, v28, v27, vcc
    v_xor_b32 v27, v24, v20
    v_xor_b32 v27, 4, v27
    v_cmp_ne_u32 vcc, 7, v27
    v_lshl_add_u32 v27, v27, 5, v26
    s_nop 1
    v_cndmask_b32 v7, v28, v27, vcc
    s_lshl_b32 s30, s17, 19
    s_lshl_b32 s21, s18, 16
    s_add_u32 s30, s30, s21
    s_mul_i32 s31, s16, 224
    s_mul_i32 s21, s19, 114688
    s_add_u32 s31, s31, s21
    s_lshl_b32 s33, s18, 12
    s_add_u32 s32, s33, 65536
    s_add_u32 s36, s33, 163840
    s_waitcnt lgkmcnt(0)
    s_add_u32 s4, s28, 0xc00000
    s_addc_u32 s5, s29, 0
    s_mov_b32 s6, 0x400000
    s_mov_b32 s7, 0x00020000
    s_cmp_eq_u32 s20, 0
    s_cselect_b32 s8, s24, s26
    s_cselect_b32 s9, s25, s27
    s_mov_b32 s10, 7340032
    s_mov_b32 s11, 0x00020000
    s_add_u32 m0, s33, 0
    s_add_u32 s34, s31, 0
    buffer_load_dwordx4 v6, s[8:11], s34 offen lds
    s_add_u32 m0, s33, 1024
    s_add_u32 s34, s31, 28672
    buffer_load_dwordx4 v6, s[8:11], s34 offen lds
    s_add_u32 m0, s33, 2048
    s_add_u32 s34, s31, 57344
    buffer_load_dwordx4 v7, s[8:11], s34 offen lds
    s_add_u32 m0, s33, 3072
    s_add_u32 s34, s31, 86016
    buffer_load_dwordx4 v7, s[8:11], s34 offen lds
    s_add_u32 s31, s31, 458752
    s_add_u32 m0, s32, 0
    s_add_u32 s34, s30, 0
    buffer_load_dwordx4 v4, s[4:7], s34 offen lds
    s_add_u32 m0, s32, 1024
    s_add_u32 s34, s30, 16384
    buffer_load_dwordx4 v5, s[4:7], s34 offen lds
    s_add_u32 m0, s32, 2048
    s_add_u32 s34, s30, 32768
    buffer_load_dwordx4 v4, s[4:7], s34 offen lds
    s_add_u32 m0, s32, 3072
    s_add_u32 s34, s30, 49152
    buffer_load_dwordx4 v5, s[4:7], s34 offen lds
    s_add_u32 s30, s30, 128
    s_add_u32 s32, s32, 32768
    s_cmp_ge_u32 s32, s36
    s_cselect_b32 s37, 98304, 0
    s_sub_u32 s32, s32, s37
    s_barrier
    s_add_u32 m0, s33, 32768
    s_add_u32 s34, s31, 0
    buffer_load_dwordx4 v6, s[8:11], s34 offen lds
    s_add_u32 m0, s33, 33792
    s_add_u32 s34, s31, 28672
    buffer_load_dwordx4 v6, s[8:11], s34 offen lds
    s_add_u32 m0, s33, 34816
    s_add_u32 s34, s31, 57344
    buffer_load_dwordx4 v7, s[8:11], s34 offen lds
    s_add_u32 m0, s33, 35840
    s_add_u32 s34, s31, 86016
    buffer_load_dwordx4 v7, s[8:11], s34 offen lds
    s_add_u32 s31, s31, 458752
    s_add_u32 m0, s32, 0
    s_add_u32 s34, s30, 0
    buffer_load_dwordx4 v4, s[4:7], s34 offen lds
    s_add_u32 m0, s32, 1024
    s_add_u32 s34, s30, 16384
    buffer_load_dwordx4 v5, s[4:7], s34 offen lds
    s_add_u32 m0, s32, 2048
    s_add_u32 s34, s30, 32768
    buffer_load_dwordx4 v4, s[4:7], s34 offen lds
    s_add_u32 m0, s32, 3072
    s_add_u32 s34, s30, 49152
    buffer_load_dwordx4 v5, s[4:7], s34 offen lds
    s_add_u32 s30, s30, 128
    s_add_u32 s32, s32, 32768
    s_cmp_ge_u32 s32, s36
    s_cselect_b32 s37, 98304, 0
    s_sub_u32 s32, s32, s37
    s_add_u32 s12, s28, 0x1000000
    s_addc_u32 s13, s29, 0
    s_mov_b32 s14, 0xe00000
    s_mov_b32 s15, 0x00020000
    v_lshrrev_b32 v24, 1, v21
    v_xor_b32 v24, v24, v20
    v_lshlrev_b32 v24, 4, v24
    v_lshl_add_u32 v24, v21, 7, v24
    s_lshl_b32 s21, s19, 13
    s_add_u32 s21, s21, 65536
    v_add_u32 v18, s21, v24
    v_xor_b32 v19, 64, v18
    v_mov_b32 v8, v18
    v_mov_b32 v9, v19
    s_mov_b32 s38, 0
    s_mov_b32 s39, 0
    v_lshrrev_b32 v24, 2, v21
    v_and_b32 v25, 3, v21
    v_and_b32 v26, 1, v20
    v_lshl_or_b32 v26, v26, 2, v24
    v_lshl_add_u32 v27, v20, 3, v24
    v_lshlrev_b32 v27, 8, v27
    v_lshl_add_u32 v27, v25, 3, v27
    s_lshl_b32 s21, s20, 2
    s_add_u32 s22, s21, 0
    s_mov_b32 s23, 0
    v_xor_b32 v24, s22, v26
    v_lshl_add_u32 v24, v24, 5, v27
    v_add_u32 v10, s23, v24
    s_add_u32 s22, s21, 1
    s_mov_b32 s23, 0
    v_xor_b32 v24, s22, v26
    v_lshl_add_u32 v24, v24, 5, v27
    v_add_u32 v11, s23, v24
    s_add_u32 s22, s21, 2
    s_mov_b32 s23, 0
    v_xor_b32 v24, s22, v26
    v_lshl_add_u32 v24, v24, 5, v27
    v_add_u32 v12, s23, v24
    s_mov_b32 s22, 3
    s_lshl_b32 s23, s20, 14
    v_xor_b32 v24, s22, v26
    v_lshl_add_u32 v24, v24, 5, v27
    v_add_u32 v13, s23, v24
    s_add_u32 s22, s21, 0
    s_mov_b32 s23, 16384
    v_xor_b32 v24, s22, v26
    v_lshl_add_u32 v24, v24, 5, v27
    v_add_u32 v14, s23, v24
    s_add_u32 s22, s21, 1
    s_mov_b32 s23, 16384
    v_xor_b32 v24, s22, v26
    v_lshl_add_u32 v24, v24, 5, v27
    v_add_u32 v15, s23, v24
    s_add_u32 s22, s21, 2
    s_mov_b32 s23, 16384
    v_xor_b32 v24, s22, v26
    v_lshl_add_u32 v24, v24, 5, v27
    v_add_u32 v16, s23, v24
    s_mov_b32 s40, 0xbfb8aa3b
    s_mov_b32 s41, 0xbfb8aa3b
    s_mov_b32 s42, 1.0
    s_mov_b32 s43, 1.0
    v_mul_u32_u24 v24, 21846, v2
    v_lshrrev_b32 v24, 16, v24
    v_mul_u32_u24 v25, 3, v24
    v_sub_u32 v25, v2, v25
    s_movk_i32 s21, 7168
    v_mul_lo_u32 v24, v24, s21
    v_lshl_add_u32 v24, v25, 7, v24
    s_cmp_eq_u32 s19, 0
    s_cselect_b32 s21, 24, 0
    v_cmp_gt_u32 vcc, s21, v2
    v_mov_b32 v25, 0x80000000
    s_nop 1
    v_cndmask_b32 v31, v25, v24, vcc
    s_mul_i32 s46, s16, 224
    s_and_b32 s46, s46, 0xffffff80
    s_mul_i32 s21, s17, 57344
    s_add_u32 s46, s46, s21
    s_add_u32 s46, s46, 1835008
    v_mov_b32 v128, 0
    v_mov_b32 v129, 0
    v_mov_b32 v130, 0
    v_mov_b32 v131, 0
    v_mov_b32 v132, 0
    v_mov_b32 v133, 0
    v_mov_b32 v134, 0
    v_mov_b32 v135, 0
    v_mov_b32 v136, 0
    v_mov_b32 v137, 0
    v_mov_b32 v138, 0
    v_mov_b32 v139, 0
    v_mov_b32 v140, 0
    v_mov_b32 v141, 0
    v_mov_b32 v142, 0
    v_mov_b32 v143, 0
    v_mov_b32 v144, 0
    v_mov_b32 v145, 0
    v_mov_b32 v146, 0
    v_mov_b32 v147, 0
    v_mov_b32 v148, 0
    v_mov_b32 v149, 0
    v_mov_b32 v150, 0
    v_mov_b32 v151, 0
    v_mov_b32 v152, 0
    v_mov_b32 v153, 0
    v_mov_b32 v154, 0
    v_mov_b32 v155, 0
    v_mov_b32 v156, 0
    v_mov_b32 v157, 0
    v_mov_b32 v158, 0
    v_mov_b32 v159, 0
    v_mov_b32 v160, 0
    v_mov_b32 v161, 0
    v_mov_b32 v162, 0
    v_mov_b32 v163, 0
    v_mov_b32 v164, 0
    v_mov_b32 v165, 0
    v_mov_b32 v166, 0
    v_mov_b32 v167, 0
    v_mov_b32 v168, 0
    v_mov_b32 v169, 0
    v_mov_b32 v170, 0
    v_mov_b32 v171, 0
    v_mov_b32 v172, 0
    v_mov_b32 v173, 0
    v_mov_b32 v174, 0
    v_mov_b32 v175, 0
    v_mov_b32 v176, 0
    v_mov_b32 v177, 0
    v_mov_b32 v178, 0
    v_mov_b32 v179, 0
    v_mov_b32 v180, 0
    v_mov_b32 v181, 0
    v_mov_b32 v182, 0
    v_mov_b32 v183, 0
    v_mov_b32 v184, 0
    v_mov_b32 v185, 0
    v_mov_b32 v186, 0
    v_mov_b32 v187, 0
    v_mov_b32 v188, 0
    v_mov_b32 v189, 0
    v_mov_b32 v190, 0
    v_mov_b32 v191, 0
    v_mov_b32 v192, 0
    v_mov_b32 v193, 0
    v_mov_b32 v194, 0
    v_mov_b32 v195, 0
    v_mov_b32 v196, 0
    v_mov_b32 v197, 0
    v_mov_b32 v198, 0
    v_mov_b32 v199, 0
    v_mov_b32 v200, 0
    v_mov_b32 v201, 0
    v_mov_b32 v202, 0
    v_mov_b32 v203, 0
    v_mov_b32 v204, 0
    v_mov_b32 v205, 0
    v_mov_b32 v206, 0
    v_mov_b32 v207, 0
    v_mov_b32 v208, 0
    v_mov_b32 v209, 0
    v_mov_b32 v210, 0
    v_mov_b32 v211, 0
    v_mov_b32 v212, 0
    v_mov_b32 v213, 0
    v_mov_b32 v214, 0
    v_mov_b32 v215, 0
    v_mov_b32 v216, 0
    v_mov_b32 v217, 0
    v_mov_b32 v218, 0
    v_mov_b32 v219, 0
    v_mov_b32 v220, 0
    v_mov_b32 v221, 0
    v_mov_b32 v222, 0
    v_mov_b32 v223, 0
    v_mov_b32 v224, 0
    v_mov_b32 v225, 0
    v_mov_b32 v226, 0
    v_mov_b32 v227, 0
    v_mov_b32 v228, 0
    v_mov_b32 v229, 0
    v_mov_b32 v230, 0
    v_mov_b32 v231, 0
    v_mov_b32 v232, 0
    v_mov_b32 v233, 0
    v_mov_b32 v234, 0
    v_mov_b32 v235, 0
    v_mov_b32 v236, 0
    v_mov_b32 v237, 0
    v_mov_b32 v238, 0
    v_mov_b32 v239, 0
    s_waitcnt vmcnt(8)
    s_barrier
    ds_read_b128 v[32:35], v8 offset:0
    ds_read_b128 v[36:39], v8 offset:2048
    ds_read_b128 v[40:43], v8 offset:4096
    ds_read_b128 v[44:47], v8 offset:6144
    s_add_u32 s38, s38, 32768
    s_cmp_ge_u32 s38, 98304
    s_cselect_b32 s38, 0, s38
    v_add_u32 v8, s38, v18
    ds_read_b64_tr_b16 v[48:49], v10 offset:0
    ds_read_b64_tr_b16 v[50:51], v10 offset:1024
    ds_read_b64_tr_b16 v[52:53], v11 offset:0
    ds_read_b64_tr_b16 v[54:55], v11 offset:1024
    ds_read_b64_tr_b16 v[56:57], v12 offset:0
    ds_read_b64_tr_b16 v[58:59], v12 offset:1024
    ds_read_b64_tr_b16 v[60:61], v13 offset:0
    ds_read_b64_tr_b16 v[62:63], v13 offset:1024
    ds_read_b64_tr_b16 v[64:65], v14 offset:0
    ds_read_b64_tr_b16 v[66:67], v14 offset:1024
    ds_read_b64_tr_b16 v[68:69], v15 offset:0
    ds_read_b64_tr_b16 v[70:71], v15 offset:1024
    ds_read_b64_tr_b16 v[72:73], v16 offset:0
    ds_read_b64_tr_b16 v[74:75], v16 offset:1024
    s_waitcnt lgkmcnt(0)
    v_mfma_f32_16x16x32_bf16 v[128:131], v[48:51], v[32:35], v[128:131]
    ds_read_b128 v[76:79], v9 offset:0
    v_mfma_f32_16x16x32_bf16 v[132:135], v[48:51], v[36:39], v[132:135]
    ds_read_b128 v[80:83], v9 offset:2048
    v_mfma_f32_16x16x32_bf16 v[136:139], v[48:51], v[40:43], v[136:139]
    ds_read_b128 v[84:87], v9 offset:4096
    v_mfma_f32_16x16x32_bf16 v[140:143], v[48:51], v[44:47], v[140:143]
    ds_read_b128 v[88:91], v9 offset:6144
    s_add_u32 s39, s39, 32768
    s_cmp_ge_u32 s39, 98304
    s_cselect_b32 s39, 0, s39
    v_add_u32 v9, s39, v19
    v_mfma_f32_16x16x32_bf16 v[144:147], v[52:55], v[32:35], v[144:147]
    ds_read_b64_tr_b16 v[92:93], v10 offset:8192
    v_mfma_f32_16x16x32_bf16 v[148:151], v[52:55], v[36:39], v[148:151]
    ds_read_b64_tr_b16 v[94:95], v10 offset:9216
    v_mfma_f32_16x16x32_bf16 v[152:155], v[52:55], v[40:43], v[152:155]
    ds_read_b64_tr_b16 v[96:97], v11 offset:8192
    v_mfma_f32_16x16x32_bf16 v[156:159], v[52:55], v[44:47], v[156:159]
    ds_read_b64_tr_b16 v[98:99], v11 offset:9216
    v_mfma_f32_16x16x32_bf16 v[160:163], v[56:59], v[32:35], v[160:163]
    ds_read_b64_tr_b16 v[100:101], v12 offset:8192
    v_mfma_f32_16x16x32_bf16 v[164:167], v[56:59], v[36:39], v[164:167]
    ds_read_b64_tr_b16 v[102:103], v12 offset:9216
    v_mfma_f32_16x16x32_bf16 v[168:171], v[56:59], v[40:43], v[168:171]
    ds_read_b64_tr_b16 v[104:105], v13 offset:8192
    s_add_u32 m0, s32, 0
    s_add_u32 s34, s30, 0
    buffer_load_dwordx4 v4, s[4:7], s34 offen lds
    v_mfma_f32_16x16x32_bf16 v[172:175], v[56:59], v[44:47], v[172:175]
    ds_read_b64_tr_b16 v[106:107], v13 offset:9216
    v_mfma_f32_16x16x32_bf16 v[176:179], v[60:63], v[32:35], v[176:179]
    ds_read_b64_tr_b16 v[108:109], v14 offset:8192
    s_add_u32 m0, s32, 1024
    s_add_u32 s34, s30, 16384
    buffer_load_dwordx4 v5, s[4:7], s34 offen lds
    v_mfma_f32_16x16x32_bf16 v[180:183], v[60:63], v[36:39], v[180:183]
    ds_read_b64_tr_b16 v[110:111], v14 offset:9216
    v_mfma_f32_16x16x32_bf16 v[184:187], v[60:63], v[40:43], v[184:187]
    ds_read_b64_tr_b16 v[112:113], v15 offset:8192
    s_add_u32 m0, s32, 2048
    s_add_u32 s34, s30, 32768
    buffer_load_dwordx4 v4, s[4:7], s34 offen lds
    v_mfma_f32_16x16x32_bf16 v[188:191], v[60:63], v[44:47], v[188:191]
    ds_read_b64_tr_b16 v[114:115], v15 offset:9216
    v_mfma_f32_16x16x32_bf16 v[192:195], v[64:67], v[32:35], v[192:195]
    ds_read_b64_tr_b16 v[116:117], v16 offset:8192
    s_add_u32 m0, s32, 3072
    s_add_u32 s34, s30, 49152
    buffer_load_dwordx4 v5, s[4:7], s34 offen lds
    s_add_u32 s30, s30, 128
    s_add_u32 s32, s32, 32768
    s_cmp_ge_u32 s32, s36
    s_cselect_b32 s37, 98304, 0
    s_sub_u32 s32, s32, s37
    v_mfma_f32_16x16x32_bf16 v[196:199], v[64:67], v[36:39], v[196:199]
    ds_read_b64_tr_b16 v[118:119], v16 offset:9216
    v_mfma_f32_16x16x32_bf16 v[200:203], v[64:67], v[40:43], v[200:203]
    v_mfma_f32_16x16x32_bf16 v[204:207], v[64:67], v[44:47], v[204:207]
    v_mfma_f32_16x16x32_bf16 v[208:211], v[68:71], v[32:35], v[208:211]
    v_mfma_f32_16x16x32_bf16 v[212:215], v[68:71], v[36:39], v[212:215]
    v_mfma_f32_16x16x32_bf16 v[216:219], v[68:71], v[40:43], v[216:219]
    v_mfma_f32_16x16x32_bf16 v[220:223], v[68:71], v[44:47], v[220:223]
    v_mfma_f32_16x16x32_bf16 v[224:227], v[72:75], v[32:35], v[224:227]
    v_mfma_f32_16x16x32_bf16 v[228:231], v[72:75], v[36:39], v[228:231]
    v_mfma_f32_16x16x32_bf16 v[232:235], v[72:75], v[40:43], v[232:235]
    v_mfma_f32_16x16x32_bf16 v[236:239], v[72:75], v[44:47], v[236:239]
    s_waitcnt vmcnt(4) lgkmcnt(0)
    s_barrier
    v_mfma_f32_16x16x32_bf16 v[128:131], v[92:95], v[76:79], v[128:131]
    ds_read_b128 v[32:35], v8 offset:0
    v_mfma_f32_16x16x32_bf16 v[132:135], v[92:95], v[80:83], v[132:135]
    ds_read_b128 v[36:39], v8 offset:2048
    s_add_u32 m0, s33, 0
    s_add_u32 s34, s31, 0
    buffer_load_dwordx4 v6, s[8:11], s34 offen lds
    v_mfma_f32_16x16x32_bf16 v[136:139], v[92:95], v[84:87], v[136:139]
    ds_read_b128 v[40:43], v8 offset:4096
    v_mfma_f32_16x16x32_bf16 v[140:143], v[92:95], v[88:91], v[140:143]
    ds_read_b128 v[44:47], v8 offset:6144
    s_add_u32 s38, s38, 32768
    s_cmp_ge_u32 s38, 98304
    s_cselect_b32 s38, 0, s38
    v_add_u32 v8, s38, v18
    v_mfma_f32_16x16x32_bf16 v[144:147], v[96:99], v[76:79], v[144:147]
    ds_read_b64_tr_b16 v[48:49], v10 offset:32768
    s_add_u32 m0, s33, 1024
    s_add_u32 s34, s31, 28672
    buffer_load_dwordx4 v6, s[8:11], s34 offen lds
    v_mfma_f32_16x16x32_bf16 v[148:151], v[96:99], v[80:83], v[148:151]
    ds_read_b64_tr_b16 v[50:51], v10 offset:33792
    v_mfma_f32_16x16x32_bf16 v[152:155], v[96:99], v[84:87], v[152:155]
    ds_read_b64_tr_b16 v[52:53], v11 offset:32768
    v_mfma_f32_16x16x32_bf16 v[156:159], v[96:99], v[88:91], v[156:159]
    ds_read_b64_tr_b16 v[54:55], v11 offset:33792
    s_add_u32 m0, s33, 2048
    s_add_u32 s34, s31, 57344
    buffer_load_dwordx4 v7, s[8:11], s34 offen lds
    v_mfma_f32_16x16x32_bf16 v[160:163], v[100:103], v[76:79], v[160:163]
    ds_read_b64_tr_b16 v[56:57], v12 offset:32768
    v_mfma_f32_16x16x32_bf16 v[164:167], v[100:103], v[80:83], v[164:167]
    ds_read_b64_tr_b16 v[58:59], v12 offset:33792
    v_mfma_f32_16x16x32_bf16 v[168:171], v[100:103], v[84:87], v[168:171]
    ds_read_b64_tr_b16 v[60:61], v13 offset:32768
    s_add_u32 m0, s33, 3072
    s_add_u32 s34, s31, 86016
    buffer_load_dwordx4 v7, s[8:11], s34 offen lds
    s_add_u32 s31, s31, 458752
    v_mfma_f32_16x16x32_bf16 v[172:175], v[100:103], v[88:91], v[172:175]
    ds_read_b64_tr_b16 v[62:63], v13 offset:33792
    v_mfma_f32_16x16x32_bf16 v[176:179], v[104:107], v[76:79], v[176:179]
    ds_read_b64_tr_b16 v[64:65], v14 offset:32768
    v_mfma_f32_16x16x32_bf16 v[180:183], v[104:107], v[80:83], v[180:183]
    ds_read_b64_tr_b16 v[66:67], v14 offset:33792
    s_add_u32 m0, s32, 0
    s_add_u32 s34, s30, 0
    buffer_load_dwordx4 v4, s[4:7], s34 offen lds
    v_mfma_f32_16x16x32_bf16 v[184:187], v[104:107], v[84:87], v[184:187]
    ds_read_b64_tr_b16 v[68:69], v15 offset:32768
    v_mfma_f32_16x16x32_bf16 v[188:191], v[104:107], v[88:91], v[188:191]
    ds_read_b64_tr_b16 v[70:71], v15 offset:33792
    v_mfma_f32_16x16x32_bf16 v[192:195], v[108:111], v[76:79], v[192:195]
    ds_read_b64_tr_b16 v[72:73], v16 offset:32768
    s_add_u32 m0, s32, 1024
    s_add_u32 s34, s30, 16384
    buffer_load_dwordx4 v5, s[4:7], s34 offen lds
    v_mfma_f32_16x16x32_bf16 v[196:199], v[108:111], v[80:83], v[196:199]
    ds_read_b64_tr_b16 v[74:75], v16 offset:33792
    v_mfma_f32_16x16x32_bf16 v[200:203], v[108:111], v[84:87], v[200:203]
    v_mfma_f32_16x16x32_bf16 v[204:207], v[108:111], v[88:91], v[204:207]
    s_add_u32 m0, s32, 2048
    s_add_u32 s34, s30, 32768
    buffer_load_dwordx4 v4, s[4:7], s34 offen lds
    v_mfma_f32_16x16x32_bf16 v[208:211], v[112:115], v[76:79], v[208:211]
    v_mfma_f32_16x16x32_bf16 v[212:215], v[112:115], v[80:83], v[212:215]
    v_mfma_f32_16x16x32_bf16 v[216:219], v[112:115], v[84:87], v[216:219]
    s_add_u32 m0, s32, 3072
    s_add_u32 s34, s30, 49152
    buffer_load_dwordx4 v5, s[4:7], s34 offen lds
    s_add_u32 s30, s30, 128
    s_add_u32 s32, s32, 32768
    s_cmp_ge_u32 s32, s36
    s_cselect_b32 s37, 98304, 0
    s_sub_u32 s32, s32, s37
    v_mfma_f32_16x16x32_bf16 v[220:223], v[112:115], v[88:91], v[220:223]
    v_mfma_f32_16x16x32_bf16 v[224:227], v[116:119], v[76:79], v[224:227]
    v_mfma_f32_16x16x32_bf16 v[228:231], v[116:119], v[80:83], v[228:231]
    buffer_load_dword v30, v31, s[8:11], s46 offen
    s_add_u32 s46, s46, 458752
    v_mfma_f32_16x16x32_bf16 v[232:235], v[116:119], v[84:87], v[232:235]
    v_mfma_f32_16x16x32_bf16 v[236:239], v[116:119], v[88:91], v[236:239]
    s_waitcnt lgkmcnt(0)
    v_mfma_f32_16x16x32_bf16 v[128:131], v[48:51], v[32:35], v[128:131]
    ds_read_b128 v[76:79], v9 offset:0
    v_mfma_f32_16x16x32_bf16 v[132:135], v[48:51], v[36:39], v[132:135]
    ds_read_b128 v[80:83], v9 offset:2048
    v_mfma_f32_16x16x32_bf16 v[136:139], v[48:51], v[40:43], v[136:139]
    ds_read_b128 v[84:87], v9 offset:4096
    v_mfma_f32_16x16x32_bf16 v[140:143], v[48:51], v[44:47], v[140:143]
    ds_read_b128 v[88:91], v9 offset:6144
    s_add_u32 s39, s39, 32768
    s_cmp_ge_u32 s39, 98304
    s_cselect_b32 s39, 0, s39
    v_add_u32 v9, s39, v19
    v_mfma_f32_16x16x32_bf16 v[144:147], v[52:55], v[32:35], v[144:147]
    ds_read_b64_tr_b16 v[92:93], v10 offset:40960
    v_mfma_f32_16x16x32_bf16 v[148:151], v[52:55], v[36:39], v[148:151]
    ds_read_b64_tr_b16 v[94:95], v10 offset:41984
    v_mfma_f32_16x16x32_bf16 v[152:155], v[52:55], v[40:43], v[152:155]
    ds_read_b64_tr_b16 v[96:97], v11 offset:40960
    v_mfma_f32_16x16x32_bf16 v[156:159], v[52:55], v[44:47], v[156:159]
    ds_read_b64_tr_b16 v[98:99], v11 offset:41984
    v_mfma_f32_16x16x32_bf16 v[160:163], v[56:59], v[32:35], v[160:163]
    ds_read_b64_tr_b16 v[100:101], v12 offset:40960
    v_mfma_f32_16x16x32_bf16 v[164:167], v[56:59], v[36:39], v[164:167]
    ds_read_b64_tr_b16 v[102:103], v12 offset:41984
    v_mfma_f32_16x16x32_bf16 v[168:171], v[56:59], v[40:43], v[168:171]
    ds_read_b64_tr_b16 v[104:105], v13 offset:40960
    v_mfma_f32_16x16x32_bf16 v[172:175], v[56:59], v[44:47], v[172:175]
    ds_read_b64_tr_b16 v[106:107], v13 offset:41984
    v_mfma_f32_16x16x32_bf16 v[176:179], v[60:63], v[32:35], v[176:179]
    ds_read_b64_tr_b16 v[108:109], v14 offset:40960
    v_mfma_f32_16x16x32_bf16 v[180:183], v[60:63], v[36:39], v[180:183]
    ds_read_b64_tr_b16 v[110:111], v14 offset:41984
    v_mfma_f32_16x16x32_bf16 v[184:187], v[60:63], v[40:43], v[184:187]
    ds_read_b64_tr_b16 v[112:113], v15 offset:40960
    v_mfma_f32_16x16x32_bf16 v[188:191], v[60:63], v[44:47], v[188:191]
    ds_read_b64_tr_b16 v[114:115], v15 offset:41984
    v_mfma_f32_16x16x32_bf16 v[192:195], v[64:67], v[32:35], v[192:195]
    ds_read_b64_tr_b16 v[116:117], v16 offset:40960
    v_mfma_f32_16x16x32_bf16 v[196:199], v[64:67], v[36:39], v[196:199]
    ds_read_b64_tr_b16 v[118:119], v16 offset:41984
    v_mfma_f32_16x16x32_bf16 v[200:203], v[64:67], v[40:43], v[200:203]
    v_mfma_f32_16x16x32_bf16 v[204:207], v[64:67], v[44:47], v[204:207]
    v_mfma_f32_16x16x32_bf16 v[208:211], v[68:71], v[32:35], v[208:211]
    v_mfma_f32_16x16x32_bf16 v[212:215], v[68:71], v[36:39], v[212:215]
    v_mfma_f32_16x16x32_bf16 v[216:219], v[68:71], v[40:43], v[216:219]
    v_mfma_f32_16x16x32_bf16 v[220:223], v[68:71], v[44:47], v[220:223]
    v_mfma_f32_16x16x32_bf16 v[224:227], v[72:75], v[32:35], v[224:227]
    v_mfma_f32_16x16x32_bf16 v[228:231], v[72:75], v[36:39], v[228:231]
    v_mfma_f32_16x16x32_bf16 v[232:235], v[72:75], v[40:43], v[232:235]
    v_mfma_f32_16x16x32_bf16 v[236:239], v[72:75], v[44:47], v[236:239]
    s_waitcnt vmcnt(5) lgkmcnt(0)
    s_barrier
    v_mfma_f32_16x16x32_bf16 v[128:131], v[92:95], v[76:79], v[128:131]
    ds_read_b128 v[32:35], v8 offset:0
    v_mfma_f32_16x16x32_bf16 v[132:135], v[92:95], v[80:83], v[132:135]
    ds_read_b128 v[36:39], v8 offset:2048
    s_add_u32 m0, s33, 32768
    s_add_u32 s34, s31, 0
    buffer_load_dwordx4 v6, s[8:11], s34 offen lds
    v_mfma_f32_16x16x32_bf16 v[136:139], v[92:95], v[84:87], v[136:139]
    ds_read_b128 v[40:43], v8 offset:4096
    v_mfma_f32_16x16x32_bf16 v[140:143], v[92:95], v[88:91], v[140:143]
    ds_read_b128 v[44:47], v8 offset:6144
    s_add_u32 s38, s38, 32768
    s_cmp_ge_u32 s38, 98304
    s_cselect_b32 s38, 0, s38
    v_add_u32 v8, s38, v18
    v_mfma_f32_16x16x32_bf16 v[144:147], v[96:99], v[76:79], v[144:147]
    ds_read_b64_tr_b16 v[48:49], v10 offset:0
    s_add_u32 m0, s33, 33792
    s_add_u32 s34, s31, 28672
    buffer_load_dwordx4 v6, s[8:11], s34 offen lds
    v_mfma_f32_16x16x32_bf16 v[148:151], v[96:99], v[80:83], v[148:151]
    ds_read_b64_tr_b16 v[50:51], v10 offset:1024
    v_mfma_f32_16x16x32_bf16 v[152:155], v[96:99], v[84:87], v[152:155]
    ds_read_b64_tr_b16 v[52:53], v11 offset:0
    v_mfma_f32_16x16x32_bf16 v[156:159], v[96:99], v[88:91], v[156:159]
    ds_read_b64_tr_b16 v[54:55], v11 offset:1024
    s_add_u32 m0, s33, 34816
    s_add_u32 s34, s31, 57344
    buffer_load_dwordx4 v7, s[8:11], s34 offen lds
    v_mfma_f32_16x16x32_bf16 v[160:163], v[100:103], v[76:79], v[160:163]
    ds_read_b64_tr_b16 v[56:57], v12 offset:0
    v_mfma_f32_16x16x32_bf16 v[164:167], v[100:103], v[80:83], v[164:167]
    ds_read_b64_tr_b16 v[58:59], v12 offset:1024
    v_mfma_f32_16x16x32_bf16 v[168:171], v[100:103], v[84:87], v[168:171]
    ds_read_b64_tr_b16 v[60:61], v13 offset:0
    s_add_u32 m0, s33, 35840
    s_add_u32 s34, s31, 86016
    buffer_load_dwordx4 v7, s[8:11], s34 offen lds
    s_add_u32 s31, s31, 458752
    v_mfma_f32_16x16x32_bf16 v[172:175], v[100:103], v[88:91], v[172:175]
    ds_read_b64_tr_b16 v[62:63], v13 offset:1024
    v_mfma_f32_16x16x32_bf16 v[176:179], v[104:107], v[76:79], v[176:179]
    ds_read_b64_tr_b16 v[64:65], v14 offset:0
    v_mfma_f32_16x16x32_bf16 v[180:183], v[104:107], v[80:83], v[180:183]
    ds_read_b64_tr_b16 v[66:67], v14 offset:1024
    s_add_u32 m0, s32, 0
    s_add_u32 s34, s30, 0
    buffer_load_dwordx4 v4, s[4:7], s34 offen lds
    v_mfma_f32_16x16x32_bf16 v[184:187], v[104:107], v[84:87], v[184:187]
    ds_read_b64_tr_b16 v[68:69], v15 offset:0
    v_mfma_f32_16x16x32_bf16 v[188:191], v[104:107], v[88:91], v[188:191]
    ds_read_b64_tr_b16 v[70:71], v15 offset:1024
    v_mfma_f32_16x16x32_bf16 v[192:195], v[108:111], v[76:79], v[192:195]
    ds_read_b64_tr_b16 v[72:73], v16 offset:0
    s_add_u32 m0, s32, 1024
    s_add_u32 s34, s30, 16384
    buffer_load_dwordx4 v5, s[4:7], s34 offen lds
    v_mfma_f32_16x16x32_bf16 v[196:199], v[108:111], v[80:83], v[196:199]
    ds_read_b64_tr_b16 v[74:75], v16 offset:1024
    v_mfma_f32_16x16x32_bf16 v[200:203], v[108:111], v[84:87], v[200:203]
    v_mfma_f32_16x16x32_bf16 v[204:207], v[108:111], v[88:91], v[204:207]
    s_add_u32 m0, s32, 2048
    s_add_u32 s34, s30, 32768
    buffer_load_dwordx4 v4, s[4:7], s34 offen lds
    v_mfma_f32_16x16x32_bf16 v[208:211], v[112:115], v[76:79], v[208:211]
    v_mfma_f32_16x16x32_bf16 v[212:215], v[112:115], v[80:83], v[212:215]
    v_mfma_f32_16x16x32_bf16 v[216:219], v[112:115], v[84:87], v[216:219]
    s_add_u32 m0, s32, 3072
    s_add_u32 s34, s30, 49152
    buffer_load_dwordx4 v5, s[4:7], s34 offen lds
    s_add_u32 s30, s30, 128
    s_add_u32 s32, s32, 32768
    s_cmp_ge_u32 s32, s36
    s_cselect_b32 s37, 98304, 0
    s_sub_u32 s32, s32, s37
    v_mfma_f32_16x16x32_bf16 v[220:223], v[112:115], v[88:91], v[220:223]
    v_mfma_f32_16x16x32_bf16 v[224:227], v[116:119], v[76:79], v[224:227]
    v_mfma_f32_16x16x32_bf16 v[228:231], v[116:119], v[80:83], v[228:231]
    buffer_load_dword v30, v31, s[8:11], s46 offen
    s_add_u32 s46, s46, 458752
    v_mfma_f32_16x16x32_bf16 v[232:235], v[116:119], v[84:87], v[232:235]
    v_mfma_f32_16x16x32_bf16 v[236:239], v[116:119], v[88:91], v[236:239]
    s_mov_b32 s35, 0
Lg1_loop:
    s_waitcnt lgkmcnt(0)
    v_mfma_f32_16x16x32_bf16 v[128:131], v[48:51], v[32:35], v[128:131]
    ds_read_b128 v[76:79], v9 offset:0
    v_mfma_f32_16x16x32_bf16 v[132:135], v[48:51], v[36:39], v[132:135]
    ds_read_b128 v[80:83], v9 offset:2048
    v_mfma_f32_16x16x32_bf16 v[136:139], v[48:51], v[40:43], v[136:139]
    ds_read_b128 v[84:87], v9 offset:4096
    v_mfma_f32_16x16x32_bf16 v[140:143], v[48:51], v[44:47], v[140:143]
    ds_read_b128 v[88:91], v9 offset:6144
    s_add_u32 s39, s39, 32768
    s_cmp_ge_u32 s39, 98304
    s_cselect_b32 s39, 0, s39
    v_add_u32 v9, s39, v19
    v_mfma_f32_16x16x32_bf16 v[144:147], v[52:55], v[32:35], v[144:147]
    ds_read_b64_tr_b16 v[92:93], v10 offset:8192
    v_mfma_f32_16x16x32_bf16 v[148:151], v[52:55], v[36:39], v[148:151]
    ds_read_b64_tr_b16 v[94:95], v10 offset:9216
    v_mfma_f32_16x16x32_bf16 v[152:155], v[52:55], v[40:43], v[152:155]
    ds_read_b64_tr_b16 v[96:97], v11 offset:8192
    v_mfma_f32_16x16x32_bf16 v[156:159], v[52:55], v[44:47], v[156:159]
    ds_read_b64_tr_b16 v[98:99], v11 offset:9216
    v_mfma_f32_16x16x32_bf16 v[160:163], v[56:59], v[32:35], v[160:163]
    ds_read_b64_tr_b16 v[100:101], v12 offset:8192
    v_mfma_f32_16x16x32_bf16 v[164:167], v[56:59], v[36:39], v[164:167]
    ds_read_b64_tr_b16 v[102:103], v12 offset:9216
    v_mfma_f32_16x16x32_bf16 v[168:171], v[56:59], v[40:43], v[168:171]
    ds_read_b64_tr_b16 v[104:105], v13 offset:8192
    v_mfma_f32_16x16x32_bf16 v[172:175], v[56:59], v[44:47], v[172:175]
    ds_read_b64_tr_b16 v[106:107], v13 offset:9216
    v_mfma_f32_16x16x32_bf16 v[176:179], v[60:63], v[32:35], v[176:179]
    ds_read_b64_tr_b16 v[108:109], v14 offset:8192
    v_mfma_f32_16x16x32_bf16 v[180:183], v[60:63], v[36:39], v[180:183]
    ds_read_b64_tr_b16 v[110:111], v14 offset:9216
    v_mfma_f32_16x16x32_bf16 v[184:187], v[60:63], v[40:43], v[184:187]
    ds_read_b64_tr_b16 v[112:113], v15 offset:8192
    v_mfma_f32_16x16x32_bf16 v[188:191], v[60:63], v[44:47], v[188:191]
    ds_read_b64_tr_b16 v[114:115], v15 offset:9216
    v_mfma_f32_16x16x32_bf16 v[192:195], v[64:67], v[32:35], v[192:195]
    ds_read_b64_tr_b16 v[116:117], v16 offset:8192
    v_mfma_f32_16x16x32_bf16 v[196:199], v[64:67], v[36:39], v[196:199]
    ds_read_b64_tr_b16 v[118:119], v16 offset:9216
    v_mfma_f32_16x16x32_bf16 v[200:203], v[64:67], v[40:43], v[200:203]
    v_mfma_f32_16x16x32_bf16 v[204:207], v[64:67], v[44:47], v[204:207]
    v_mfma_f32_16x16x32_bf16 v[208:211], v[68:71], v[32:35], v[208:211]
    v_mfma_f32_16x16x32_bf16 v[212:215], v[68:71], v[36:39], v[212:215]
    v_mfma_f32_16x16x32_bf16 v[216:219], v[68:71], v[40:43], v[216:219]
    v_mfma_f32_16x16x32_bf16 v[220:223], v[68:71], v[44:47], v[220:223]
    v_mfma_f32_16x16x32_bf16 v[224:227], v[72:75], v[32:35], v[224:227]
    v_mfma_f32_16x16x32_bf16 v[228:231], v[72:75], v[36:39], v[228:231]
    v_mfma_f32_16x16x32_bf16 v[232:235], v[72:75], v[40:43], v[232:235]
    v_mfma_f32_16x16x32_bf16 v[236:239], v[72:75], v[44:47], v[236:239]
    s_waitcnt vmcnt(5) lgkmcnt(0)
    s_barrier
    v_mfma_f32_16x16x32_bf16 v[128:131], v[92:95], v[76:79], v[128:131]
    ds_read_b128 v[32:35], v8 offset:0
    v_mfma_f32_16x16x32_bf16 v[132:135], v[92:95], v[80:83], v[132:135]
    ds_read_b128 v[36:39], v8 offset:2048
    s_add_u32 m0, s33, 0
    s_add_u32 s34, s31, 0
    buffer_load_dwordx4 v6, s[8:11], s34 offen lds
    v_mfma_f32_16x16x32_bf16 v[136:139], v[92:95], v[84:87], v[136:139]
    ds_read_b128 v[40:43], v8 offset:4096
    v_mfma_f32_16x16x32_bf16 v[140:143], v[92:95], v[88:91], v[140:143]
    ds_read_b128 v[44:47], v8 offset:6144
    s_add_u32 s38, s38, 32768
    s_cmp_ge_u32 s38, 98304
    s_cselect_b32 s38, 0, s38
    v_add_u32 v8, s38, v18
    v_mfma_f32_16x16x32_bf16 v[144:147], v[96:99], v[76:79], v[144:147]
    ds_read_b64_tr_b16 v[48:49], v10 offset:32768
    s_add_u32 m0, s33, 1024
    s_add_u32 s34, s31, 28672
    buffer_load_dwordx4 v6, s[8:11], s34 offen lds
    v_mfma_f32_16x16x32_bf16 v[148:151], v[96:99], v[80:83], v[148:151]
    ds_read_b64_tr_b16 v[50:51], v10 offset:33792
    v_mfma_f32_16x16x32_bf16 v[152:155], v[96:99], v[84:87], v[152:155]
    ds_read_b64_tr_b16 v[52:53], v11 offset:32768
    v_mfma_f32_16x16x32_bf16 v[156:159], v[96:99], v[88:91], v[156:159]
    ds_read_b64_tr_b16 v[54:55], v11 offset:33792
    s_add_u32 m0, s33, 2048
    s_add_u32 s34, s31, 57344
    buffer_load_dwordx4 v7, s[8:11], s34 offen lds
    v_mfma_f32_16x16x32_bf16 v[160:163], v[100:103], v[76:79], v[160:163]
    ds_read_b64_tr_b16 v[56:57], v12 offset:32768
    v_mfma_f32_16x16x32_bf16 v[164:167], v[100:103], v[80:83], v[164:167]
    ds_read_b64_tr_b16 v[58:59], v12 offset:33792
    v_mfma_f32_16x16x32_bf16 v[168:171], v[100:103], v[84:87], v[168:171]
    ds_read_b64_tr_b16 v[60:61], v13 offset:32768
    s_add_u32 m0, s33, 3072
    s_add_u32 s34, s31, 86016
    buffer_load_dwordx4 v7, s[8:11], s34 offen lds
    s_add_u32 s31, s31, 458752
    v_mfma_f32_16x16x32_bf16 v[172:175], v[100:103], v[88:91], v[172:175]
    ds_read_b64_tr_b16 v[62:63], v13 offset:33792
    v_mfma_f32_16x16x32_bf16 v[176:179], v[104:107], v[76:79], v[176:179]
    ds_read_b64_tr_b16 v[64:65], v14 offset:32768
    v_mfma_f32_16x16x32_bf16 v[180:183], v[104:107], v[80:83], v[180:183]
    ds_read_b64_tr_b16 v[66:67], v14 offset:33792
    s_add_u32 m0, s32, 0
    s_add_u32 s34, s30, 0
    buffer_load_dwordx4 v4, s[4:7], s34 offen lds
    v_mfma_f32_16x16x32_bf16 v[184:187], v[104:107], v[84:87], v[184:187]
    ds_read_b64_tr_b16 v[68:69], v15 offset:32768
    v_mfma_f32_16x16x32_bf16 v[188:191], v[104:107], v[88:91], v[188:191]
    ds_read_b64_tr_b16 v[70:71], v15 offset:33792
    v_mfma_f32_16x16x32_bf16 v[192:195], v[108:111], v[76:79], v[192:195]
    ds_read_b64_tr_b16 v[72:73], v16 offset:32768
    s_add_u32 m0, s32, 1024
    s_add_u32 s34, s30, 16384
    buffer_load_dwordx4 v5, s[4:7], s34 offen lds
    v_mfma_f32_16x16x32_bf16 v[196:199], v[108:111], v[80:83], v[196:199]
    ds_read_b64_tr_b16 v[74:75], v16 offset:33792
    v_mfma_f32_16x16x32_bf16 v[200:203], v[108:111], v[84:87], v[200:203]
    v_mfma_f32_16x16x32_bf16 v[204:207], v[108:111], v[88:91], v[204:207]
    s_add_u32 m0, s32, 2048
    s_add_u32 s34, s30, 32768
    buffer_load_dwordx4 v4, s[4:7], s34 offen lds
    v_mfma_f32_16x16x32_bf16 v[208:211], v[112:115], v[76:79], v[208:211]
    v_mfma_f32_16x16x32_bf16 v[212:215], v[112:115], v[80:83], v[212:215]
    v_mfma_f32_16x16x32_bf16 v[216:219], v[112:115], v[84:87], v[216:219]
    s_add_u32 m0, s32, 3072
    s_add_u32 s34, s30, 49152
    buffer_load_dwordx4 v5, s[4:7], s34 offen lds
    s_add_u32 s30, s30, 128
    s_add_u32 s32, s32, 32768
    s_cmp_ge_u32 s32, s36
    s_cselect_b32 s37, 98304, 0
    s_sub_u32 s32, s32, s37
    v_mfma_f32_16x16x32_bf16 v[220:223], v[112:115], v[88:91], v[220:223]
    v_mfma_f32_16x16x32_bf16 v[224:227], v[116:119], v[76:79], v[224:227]
    v_mfma_f32_16x16x32_bf16 v[228:231], v[116:119], v[80:83], v[228:231]
    buffer_load_dword v30, v31, s[8:11], s46 offen
    s_add_u32 s46, s46, 458752
    v_mfma_f32_16x16x32_bf16 v[232:235], v[116:119], v[84:87], v[232:235]
    v_mfma_f32_16x16x32_bf16 v[236:239], v[116:119], v[88:91], v[236:239]
    s_waitcnt lgkmcnt(0)
    v_mfma_f32_16x16x32_bf16 v[128:131], v[48:51], v[32:35], v[128:131]
    ds_read_b128 v[76:79], v9 offset:0
    v_mfma_f32_16x16x32_bf16 v[132:135], v[48:51], v[36:39], v[132:135]
    ds_read_b128 v[80:83], v9 offset:2048
    v_mfma_f32_16x16x32_bf16 v[136:139], v[48:51], v[40:43], v[136:139]
    ds_read_b128 v[84:87], v9 offset:4096
    v_mfma_f32_16x16x32_bf16 v[140:143], v[48:51], v[44:47], v[140:143]
    ds_read_b128 v[88:91], v9 offset:6144
    s_add_u32 s39, s39, 32768
    s_cmp_ge_u32 s39, 98304
    s_cselect_b32 s39, 0, s39
    v_add_u32 v9, s39, v19
    v_mfma_f32_16x16x32_bf16 v[144:147], v[52:55], v[32:35], v[144:147]
    ds_read_b64_tr_b16 v[92:93], v10 offset:40960
    v_mfma_f32_16x16x32_bf16 v[148:151], v[52:55], v[36:39], v[148:151]
    ds_read_b64_tr_b16 v[94:95], v10 offset:41984
    v_mfma_f32_16x16x32_bf16 v[152:155], v[52:55], v[40:43], v[152:155]
    ds_read_b64_tr_b16 v[96:97], v11 offset:40960
    v_mfma_f32_16x16x32_bf16 v[156:159], v[52:55], v[44:47], v[156:159]
    ds_read_b64_tr_b16 v[98:99], v11 offset:41984
    v_mfma_f32_16x16x32_bf16 v[160:163], v[56:59], v[32:35], v[160:163]
    ds_read_b64_tr_b16 v[100:101], v12 offset:40960
    v_mfma_f32_16x16x32_bf16 v[164:167], v[56:59], v[36:39], v[164:167]
    ds_read_b64_tr_b16 v[102:103], v12 offset:41984
    v_mfma_f32_16x16x32_bf16 v[168:171], v[56:59], v[40:43], v[168:171]
    ds_read_b64_tr_b16 v[104:105], v13 offset:40960
    v_mfma_f32_16x16x32_bf16 v[172:175], v[56:59], v[44:47], v[172:175]
    ds_read_b64_tr_b16 v[106:107], v13 offset:41984
    v_mfma_f32_16x16x32_bf16 v[176:179], v[60:63], v[32:35], v[176:179]
    ds_read_b64_tr_b16 v[108:109], v14 offset:40960
    v_mfma_f32_16x16x32_bf16 v[180:183], v[60:63], v[36:39], v[180:183]
    ds_read_b64_tr_b16 v[110:111], v14 offset:41984
    v_mfma_f32_16x16x32_bf16 v[184:187], v[60:63], v[40:43], v[184:187]
    ds_read_b64_tr_b16 v[112:113], v15 offset:40960
    v_mfma_f32_16x16x32_bf16 v[188:191], v[60:63], v[44:47], v[188:191]
    ds_read_b64_tr_b16 v[114:115], v15 offset:41984
    v_mfma_f32_16x16x32_bf16 v[192:195], v[64:67], v[32:35], v[192:195]
    ds_read_b64_tr_b16 v[116:117], v16 offset:40960
    v_mfma_f32_16x16x32_bf16 v[196:199], v[64:67], v[36:39], v[196:199]
    ds_read_b64_tr_b16 v[118:119], v16 offset:41984
    v_mfma_f32_16x16x32_bf16 v[200:203], v[64:67], v[40:43], v[200:203]
    v_mfma_f32_16x16x32_bf16 v[204:207], v[64:67], v[44:47], v[204:207]
    v_mfma_f32_16x16x32_bf16 v[208:211], v[68:71], v[32:35], v[208:211]
    v_mfma_f32_16x16x32_bf16 v[212:215], v[68:71], v[36:39], v[212:215]
    v_mfma_f32_16x16x32_bf16 v[216:219], v[68:71], v[40:43], v[216:219]
    v_mfma_f32_16x16x32_bf16 v[220:223], v[68:71], v[44:47], v[220:223]
    v_mfma_f32_16x16x32_bf16 v[224:227], v[72:75], v[32:35], v[224:227]
    v_mfma_f32_16x16x32_bf16 v[228:231], v[72:75], v[36:39], v[228:231]
    v_mfma_f32_16x16x32_bf16 v[232:235], v[72:75], v[40:43], v[232:235]
    v_mfma_f32_16x16x32_bf16 v[236:239], v[72:75], v[44:47], v[236:239]
    s_waitcnt vmcnt(5) lgkmcnt(0)
    s_barrier
    v_mfma_f32_16x16x32_bf16 v[128:131], v[92:95], v[76:79], v[128:131]
    ds_read_b128 v[32:35], v8 offset:0
    v_mfma_f32_16x16x32_bf16 v[132:135], v[92:95], v[80:83], v[132:135]
    ds_read_b128 v[36:39], v8 offset:2048
    s_add_u32 m0, s33, 32768
    s_add_u32 s34, s31, 0
    buffer_load_dwordx4 v6, s[8:11], s34 offen lds
    v_mfma_f32_16x16x32_bf16 v[136:139], v[92:95], v[84:87], v[136:139]
    ds_read_b128 v[40:43], v8 offset:4096
    v_mfma_f32_16x16x32_bf16 v[140:143], v[92:95], v[88:91], v[140:143]
    ds_read_b128 v[44:47], v8 offset:6144
    s_add_u32 s38, s38, 32768
    s_cmp_ge_u32 s38, 98304
    s_cselect_b32 s38, 0, s38
    v_add_u32 v8, s38, v18
    v_mfma_f32_16x16x32_bf16 v[144:147], v[96:99], v[76:79], v[144:147]
    ds_read_b64_tr_b16 v[48:49], v10 offset:0
    s_add_u32 m0, s33, 33792
    s_add_u32 s34, s31, 28672
    buffer_load_dwordx4 v6, s[8:11], s34 offen lds
    v_mfma_f32_16x16x32_bf16 v[148:151], v[96:99], v[80:83], v[148:151]
    ds_read_b64_tr_b16 v[50:51], v10 offset:1024
    v_mfma_f32_16x16x32_bf16 v[152:155], v[96:99], v[84:87], v[152:155]
    ds_read_b64_tr_b16 v[52:53], v11 offset:0
    v_mfma_f32_16x16x32_bf16 v[156:159], v[96:99], v[88:91], v[156:159]
    ds_read_b64_tr_b16 v[54:55], v11 offset:1024
    s_add_u32 m0, s33, 34816
    s_add_u32 s34, s31, 57344
    buffer_load_dwordx4 v7, s[8:11], s34 offen lds
    v_mfma_f32_16x16x32_bf16 v[160:163], v[100:103], v[76:79], v[160:163]
    ds_read_b64_tr_b16 v[56:57], v12 offset:0
    v_mfma_f32_16x16x32_bf16 v[164:167], v[100:103], v[80:83], v[164:167]
    ds_read_b64_tr_b16 v[58:59], v12 offset:1024
    v_mfma_f32_16x16x32_bf16 v[168:171], v[100:103], v[84:87], v[168:171]
    ds_read_b64_tr_b16 v[60:61], v13 offset:0
    s_add_u32 m0, s33, 35840
    s_add_u32 s34, s31, 86016
    buffer_load_dwordx4 v7, s[8:11], s34 offen lds
    s_add_u32 s31, s31, 458752
    v_mfma_f32_16x16x32_bf16 v[172:175], v[100:103], v[88:91], v[172:175]
    ds_read_b64_tr_b16 v[62:63], v13 offset:1024
    v_mfma_f32_16x16x32_bf16 v[176:179], v[104:107], v[76:79], v[176:179]
    ds_read_b64_tr_b16 v[64:65], v14 offset:0
    v_mfma_f32_16x16x32_bf16 v[180:183], v[104:107], v[80:83], v[180:183]
    ds_read_b64_tr_b16 v[66:67], v14 offset:1024
    s_add_u32 m0, s32, 0
    s_add_u32 s34, s30, 0
    buffer_load_dwordx4 v4, s[4:7], s34 offen lds
    v_mfma_f32_16x16x32_bf16 v[184:187], v[104:107], v[84:87], v[184:187]
    ds_read_b64_tr_b16 v[68:69], v15 offset:0
    v_mfma_f32_16x16x32_bf16 v[188:191], v[104:107], v[88:91], v[188:191]
    ds_read_b64_tr_b16 v[70:71], v15 offset:1024
    v_mfma_f32_16x16x32_bf16 v[192:195], v[108:111], v[76:79], v[192:195]
    ds_read_b64_tr_b16 v[72:73], v16 offset:0
    s_add_u32 m0, s32, 1024
    s_add_u32 s34, s30, 16384
    buffer_load_dwordx4 v5, s[4:7], s34 offen lds
    v_mfma_f32_16x16x32_bf16 v[196:199], v[108:111], v[80:83], v[196:199]
    ds_read_b64_tr_b16 v[74:75], v16 offset:1024
    v_mfma_f32_16x16x32_bf16 v[200:203], v[108:111], v[84:87], v[200:203]
    v_mfma_f32_16x16x32_bf16 v[204:207], v[108:111], v[88:91], v[204:207]
    s_add_u32 m0, s32, 2048
    s_add_u32 s34, s30, 32768
    buffer_load_dwordx4 v4, s[4:7], s34 offen lds
    v_mfma_f32_16x16x32_bf16 v[208:211], v[112:115], v[76:79], v[208:211]
    v_mfma_f32_16x16x32_bf16 v[212:215], v[112:115], v[80:83], v[212:215]
    v_mfma_f32_16x16x32_bf16 v[216:219], v[112:115], v[84:87], v[216:219]
    s_add_u32 m0, s32, 3072
    s_add_u32 s34, s30, 49152
    buffer_load_dwordx4 v5, s[4:7], s34 offen lds
    s_add_u32 s30, s30, 128
    s_add_u32 s32, s32, 32768
    s_cmp_ge_u32 s32, s36
    s_cselect_b32 s37, 98304, 0
    s_sub_u32 s32, s32, s37
    v_mfma_f32_16x16x32_bf16 v[220:223], v[112:115], v[88:91], v[220:223]
    v_mfma_f32_16x16x32_bf16 v[224:227], v[116:119], v[76:79], v[224:227]
    v_mfma_f32_16x16x32_bf16 v[228:231], v[116:119], v[80:83], v[228:231]
    buffer_load_dword v30, v31, s[8:11], s46 offen
    s_add_u32 s46, s46, 458752
    v_mfma_f32_16x16x32_bf16 v[232:235], v[116:119], v[84:87], v[232:235]
    v_mfma_f32_16x16x32_bf16 v[236:239], v[116:119], v[88:91], v[236:239]
    s_add_u32 s35, s35, 1
    s_cmp_lt_u32 s35, 5
    s_cbranch_scc1 Lg1_loop
    s_waitcnt lgkmcnt(0)
    v_mfma_f32_16x16x32_bf16 v[128:131], v[48:51], v[32:35], v[128:131]
    ds_read_b128 v[76:79], v9 offset:0
    v_mfma_f32_16x16x32_bf16 v[132:135], v[48:51], v[36:39], v[132:135]
    ds_read_b128 v[80:83], v9 offset:2048
    v_mfma_f32_16x16x32_bf16 v[136:139], v[48:51], v[40:43], v[136:139]
    ds_read_b128 v[84:87], v9 offset:4096
    v_mfma_f32_16x16x32_bf16 v[140:143], v[48:51], v[44:47], v[140:143]
    ds_read_b128 v[88:91], v9 offset:6144
    s_add_u32 s39, s39, 32768
    s_cmp_ge_u32 s39, 98304
    s_cselect_b32 s39, 0, s39
    v_add_u32 v9, s39, v19
    v_mfma_f32_16x16x32_bf16 v[144:147], v[52:55], v[32:35], v[144:147]
    ds_read_b64_tr_b16 v[92:93], v10 offset:8192
    v_mfma_f32_16x16x32_bf16 v[148:151], v[52:55], v[36:39], v[148:151]
    ds_read_b64_tr_b16 v[94:95], v10 offset:9216
    v_mfma_f32_16x16x32_bf16 v[152:155], v[52:55], v[40:43], v[152:155]
    ds_read_b64_tr_b16 v[96:97], v11 offset:8192
    v_mfma_f32_16x16x32_bf16 v[156:159], v[52:55], v[44:47], v[156:159]
    ds_read_b64_tr_b16 v[98:99], v11 offset:9216
    v_mfma_f32_16x16x32_bf16 v[160:163], v[56:59], v[32:35], v[160:163]
    ds_read_b64_tr_b16 v[100:101], v12 offset:8192
    v_mfma_f32_16x16x32_bf16 v[164:167], v[56:59], v[36:39], v[164:167]
    ds_read_b64_tr_b16 v[102:103], v12 offset:9216
    v_mfma_f32_16x16x32_bf16 v[168:171], v[56:59], v[40:43], v[168:171]
    ds_read_b64_tr_b16 v[104:105], v13 offset:8192
    v_mfma_f32_16x16x32_bf16 v[172:175], v[56:59], v[44:47], v[172:175]
    ds_read_b64_tr_b16 v[106:107], v13 offset:9216
    v_mfma_f32_16x16x32_bf16 v[176:179], v[60:63], v[32:35], v[176:179]
    ds_read_b64_tr_b16 v[108:109], v14 offset:8192
    v_mfma_f32_16x16x32_bf16 v[180:183], v[60:63], v[36:39], v[180:183]
    ds_read_b64_tr_b16 v[110:111], v14 offset:9216
    v_mfma_f32_16x16x32_bf16 v[184:187], v[60:63], v[40:43], v[184:187]
    ds_read_b64_tr_b16 v[112:113], v15 offset:8192
    v_mfma_f32_16x16x32_bf16 v[188:191], v[60:63], v[44:47], v[188:191]
    ds_read_b64_tr_b16 v[114:115], v15 offset:9216
    v_mfma_f32_16x16x32_bf16 v[192:195], v[64:67], v[32:35], v[192:195]
    ds_read_b64_tr_b16 v[116:117], v16 offset:8192
    v_mfma_f32_16x16x32_bf16 v[196:199], v[64:67], v[36:39], v[196:199]
    ds_read_b64_tr_b16 v[118:119], v16 offset:9216
    v_mfma_f32_16x16x32_bf16 v[200:203], v[64:67], v[40:43], v[200:203]
    v_mfma_f32_16x16x32_bf16 v[204:207], v[64:67], v[44:47], v[204:207]
    v_mfma_f32_16x16x32_bf16 v[208:211], v[68:71], v[32:35], v[208:211]
    v_mfma_f32_16x16x32_bf16 v[212:215], v[68:71], v[36:39], v[212:215]
    v_mfma_f32_16x16x32_bf16 v[216:219], v[68:71], v[40:43], v[216:219]
    v_mfma_f32_16x16x32_bf16 v[220:223], v[68:71], v[44:47], v[220:223]
    v_mfma_f32_16x16x32_bf16 v[224:227], v[72:75], v[32:35], v[224:227]
    v_mfma_f32_16x16x32_bf16 v[228:231], v[72:75], v[36:39], v[228:231]
    v_mfma_f32_16x16x32_bf16 v[232:235], v[72:75], v[40:43], v[232:235]
    v_mfma_f32_16x16x32_bf16 v[236:239], v[72:75], v[44:47], v[236:239]
    s_waitcnt vmcnt(5) lgkmcnt(0)
    s_barrier
    v_mfma_f32_16x16x32_bf16 v[128:131], v[92:95], v[76:79], v[128:131]
    ds_read_b128 v[32:35], v8 offset:0
    v_mfma_f32_16x16x32_bf16 v[132:135], v[92:95], v[80:83], v[132:135]
    ds_read_b128 v[36:39], v8 offset:2048
    s_add_u32 m0, s33, 0
    s_add_u32 s34, s31, 0
    buffer_load_dwordx4 v6, s[8:11], s34 offen lds
    v_mfma_f32_16x16x32_bf16 v[136:139], v[92:95], v[84:87], v[136:139]
    ds_read_b128 v[40:43], v8 offset:4096
    v_mfma_f32_16x16x32_bf16 v[140:143], v[92:95], v[88:91], v[140:143]
    ds_read_b128 v[44:47], v8 offset:6144
    s_add_u32 s38, s38, 32768
    s_cmp_ge_u32 s38, 98304
    s_cselect_b32 s38, 0, s38
    v_add_u32 v8, s38, v18
    v_mfma_f32_16x16x32_bf16 v[144:147], v[96:99], v[76:79], v[144:147]
    ds_read_b64_tr_b16 v[48:49], v10 offset:32768
    s_add_u32 m0, s33, 1024
    s_add_u32 s34, s31, 28672
    buffer_load_dwordx4 v6, s[8:11], s34 offen lds
    v_mfma_f32_16x16x32_bf16 v[148:151], v[96:99], v[80:83], v[148:151]
    ds_read_b64_tr_b16 v[50:51], v10 offset:33792
    v_mfma_f32_16x16x32_bf16 v[152:155], v[96:99], v[84:87], v[152:155]
    ds_read_b64_tr_b16 v[52:53], v11 offset:32768
    v_mfma_f32_16x16x32_bf16 v[156:159], v[96:99], v[88:91], v[156:159]
    ds_read_b64_tr_b16 v[54:55], v11 offset:33792
    s_add_u32 m0, s33, 2048
    s_add_u32 s34, s31, 57344
    buffer_load_dwordx4 v7, s[8:11], s34 offen lds
    v_mfma_f32_16x16x32_bf16 v[160:163], v[100:103], v[76:79], v[160:163]
    ds_read_b64_tr_b16 v[56:57], v12 offset:32768
    v_mfma_f32_16x16x32_bf16 v[164:167], v[100:103], v[80:83], v[164:167]
    ds_read_b64_tr_b16 v[58:59], v12 offset:33792
    v_mfma_f32_16x16x32_bf16 v[168:171], v[100:103], v[84:87], v[168:171]
    ds_read_b64_tr_b16 v[60:61], v13 offset:32768
    s_add_u32 m0, s33, 3072
    s_add_u32 s34, s31, 86016
    buffer_load_dwordx4 v7, s[8:11], s34 offen lds
    s_add_u32 s31, s31, 458752
    v_mfma_f32_16x16x32_bf16 v[172:175], v[100:103], v[88:91], v[172:175]
    ds_read_b64_tr_b16 v[62:63], v13 offset:33792
    v_mfma_f32_16x16x32_bf16 v[176:179], v[104:107], v[76:79], v[176:179]
    ds_read_b64_tr_b16 v[64:65], v14 offset:32768
    v_mfma_f32_16x16x32_bf16 v[180:183], v[104:107], v[80:83], v[180:183]
    ds_read_b64_tr_b16 v[66:67], v14 offset:33792
    s_add_u32 m0, s32, 0
    s_add_u32 s34, s30, 0
    buffer_load_dwordx4 v4, s[4:7], s34 offen lds
    v_mfma_f32_16x16x32_bf16 v[184:187], v[104:107], v[84:87], v[184:187]
    ds_read_b64_tr_b16 v[68:69], v15 offset:32768
    v_mfma_f32_16x16x32_bf16 v[188:191], v[104:107], v[88:91], v[188:191]
    ds_read_b64_tr_b16 v[70:71], v15 offset:33792
    v_mfma_f32_16x16x32_bf16 v[192:195], v[108:111], v[76:79], v[192:195]
    ds_read_b64_tr_b16 v[72:73], v16 offset:32768
    s_add_u32 m0, s32, 1024
    s_add_u32 s34, s30, 16384
    buffer_load_dwordx4 v5, s[4:7], s34 offen lds
    v_mfma_f32_16x16x32_bf16 v[196:199], v[108:111], v[80:83], v[196:199]
    ds_read_b64_tr_b16 v[74:75], v16 offset:33792
    v_mfma_f32_16x16x32_bf16 v[200:203], v[108:111], v[84:87], v[200:203]
    v_mfma_f32_16x16x32_bf16 v[204:207], v[108:111], v[88:91], v[204:207]
    s_add_u32 m0, s32, 2048
    s_add_u32 s34, s30, 32768
    buffer_load_dwordx4 v4, s[4:7], s34 offen lds
    v_mfma_f32_16x16x32_bf16 v[208:211], v[112:115], v[76:79], v[208:211]
    v_mfma_f32_16x16x32_bf16 v[212:215], v[112:115], v[80:83], v[212:215]
    v_mfma_f32_16x16x32_bf16 v[216:219], v[112:115], v[84:87], v[216:219]
    s_add_u32 m0, s32, 3072
    s_add_u32 s34, s30, 49152
    buffer_load_dwordx4 v5, s[4:7], s34 offen lds
    s_add_u32 s30, s30, 128
    s_add_u32 s32, s32, 32768
    s_cmp_ge_u32 s32, s36
    s_cselect_b32 s37, 98304, 0
    s_sub_u32 s32, s32, s37
    v_mfma_f32_16x16x32_bf16 v[220:223], v[112:115], v[88:91], v[220:223]
    v_mfma_f32_16x16x32_bf16 v[224:227], v[116:119], v[76:79], v[224:227]
    v_mfma_f32_16x16x32_bf16 v[228:231], v[116:119], v[80:83], v[228:231]
    v_mfma_f32_16x16x32_bf16 v[232:235], v[116:119], v[84:87], v[232:235]
    v_mfma_f32_16x16x32_bf16 v[236:239], v[116:119], v[88:91], v[236:239]
    s_waitcnt lgkmcnt(0)
    v_mfma_f32_16x16x32_bf16 v[128:131], v[48:51], v[32:35], v[128:131]
    ds_read_b128 v[76:79], v9 offset:0
    v_mfma_f32_16x16x32_bf16 v[132:135], v[48:51], v[36:39], v[132:135]
    ds_read_b128 v[80:83], v9 offset:2048
    v_mfma_f32_16x16x32_bf16 v[136:139], v[48:51], v[40:43], v[136:139]
    ds_read_b128 v[84:87], v9 offset:4096
    v_mfma_f32_16x16x32_bf16 v[140:143], v[48:51], v[44:47], v[140:143]
    ds_read_b128 v[88:91], v9 offset:6144
    s_add_u32 s39, s39, 32768
    s_cmp_ge_u32 s39, 98304
    s_cselect_b32 s39, 0, s39
    v_add_u32 v9, s39, v19
    v_mfma_f32_16x16x32_bf16 v[144:147], v[52:55], v[32:35], v[144:147]
    ds_read_b64_tr_b16 v[92:93], v10 offset:40960
    v_mfma_f32_16x16x32_bf16 v[148:151], v[52:55], v[36:39], v[148:151]
    ds_read_b64_tr_b16 v[94:95], v10 offset:41984
    v_mfma_f32_16x16x32_bf16 v[152:155], v[52:55], v[40:43], v[152:155]
    ds_read_b64_tr_b16 v[96:97], v11 offset:40960
    v_mfma_f32_16x16x32_bf16 v[156:159], v[52:55], v[44:47], v[156:159]
    ds_read_b64_tr_b16 v[98:99], v11 offset:41984
    v_mfma_f32_16x16x32_bf16 v[160:163], v[56:59], v[32:35], v[160:163]
    ds_read_b64_tr_b16 v[100:101], v12 offset:40960
    v_mfma_f32_16x16x32_bf16 v[164:167], v[56:59], v[36:39], v[164:167]
    ds_read_b64_tr_b16 v[102:103], v12 offset:41984
    v_mfma_f32_16x16x32_bf16 v[168:171], v[56:59], v[40:43], v[168:171]
    ds_read_b64_tr_b16 v[104:105], v13 offset:40960
    v_mfma_f32_16x16x32_bf16 v[172:175], v[56:59], v[44:47], v[172:175]
    ds_read_b64_tr_b16 v[106:107], v13 offset:41984
    v_mfma_f32_16x16x32_bf16 v[176:179], v[60:63], v[32:35], v[176:179]
    ds_read_b64_tr_b16 v[108:109], v14 offset:40960
    v_mfma_f32_16x16x32_bf16 v[180:183], v[60:63], v[36:39], v[180:183]
    ds_read_b64_tr_b16 v[110:111], v14 offset:41984
    v_mfma_f32_16x16x32_bf16 v[184:187], v[60:63], v[40:43], v[184:187]
    ds_read_b64_tr_b16 v[112:113], v15 offset:40960
    v_mfma_f32_16x16x32_bf16 v[188:191], v[60:63], v[44:47], v[188:191]
    ds_read_b64_tr_b16 v[114:115], v15 offset:41984
    v_mfma_f32_16x16x32_bf16 v[192:195], v[64:67], v[32:35], v[192:195]
    ds_read_b64_tr_b16 v[116:117], v16 offset:40960
    v_mfma_f32_16x16x32_bf16 v[196:199], v[64:67], v[36:39], v[196:199]
    ds_read_b64_tr_b16 v[118:119], v16 offset:41984
    v_mfma_f32_16x16x32_bf16 v[200:203], v[64:67], v[40:43], v[200:203]
    v_mfma_f32_16x16x32_bf16 v[204:207], v[64:67], v[44:47], v[204:207]
    v_mfma_f32_16x16x32_bf16 v[208:211], v[68:71], v[32:35], v[208:211]
    v_mfma_f32_16x16x32_bf16 v[212:215], v[68:71], v[36:39], v[212:215]
    v_mfma_f32_16x16x32_bf16 v[216:219], v[68:71], v[40:43], v[216:219]
    v_mfma_f32_16x16x32_bf16 v[220:223], v[68:71], v[44:47], v[220:223]
    v_mfma_f32_16x16x32_bf16 v[224:227], v[72:75], v[32:35], v[224:227]
    v_mfma_f32_16x16x32_bf16 v[228:231], v[72:75], v[36:39], v[228:231]
    v_mfma_f32_16x16x32_bf16 v[232:235], v[72:75], v[40:43], v[232:235]
    v_mfma_f32_16x16x32_bf16 v[236:239], v[72:75], v[44:47], v[236:239]
    s_waitcnt vmcnt(4) lgkmcnt(0)
    s_barrier
    v_mfma_f32_16x16x32_bf16 v[128:131], v[92:95], v[76:79], v[128:131]
    ds_read_b128 v[32:35], v8 offset:0
    v_mfma_f32_16x16x32_bf16 v[132:135], v[92:95], v[80:83], v[132:135]
    ds_read_b128 v[36:39], v8 offset:2048
    s_add_u32 m0, s33, 32768
    s_add_u32 s34, s31, 0
    buffer_load_dwordx4 v6, s[8:11], s34 offen lds
    v_mfma_f32_16x16x32_bf16 v[136:139], v[92:95], v[84:87], v[136:139]
    ds_read_b128 v[40:43], v8 offset:4096
    v_mfma_f32_16x16x32_bf16 v[140:143], v[92:95], v[88:91], v[140:143]
    ds_read_b128 v[44:47], v8 offset:6144
    s_add_u32 s38, s38, 32768
    s_cmp_ge_u32 s38, 98304
    s_cselect_b32 s38, 0, s38
    v_add_u32 v8, s38, v18
    v_mfma_f32_16x16x32_bf16 v[144:147], v[96:99], v[76:79], v[144:147]
    ds_read_b64_tr_b16 v[48:49], v10 offset:0
    s_add_u32 m0, s33, 33792
    s_add_u32 s34, s31, 28672
    buffer_load_dwordx4 v6, s[8:11], s34 offen lds
    v_mfma_f32_16x16x32_bf16 v[148:151], v[96:99], v[80:83], v[148:151]
    ds_read_b64_tr_b16 v[50:51], v10 offset:1024
    v_mfma_f32_16x16x32_bf16 v[152:155], v[96:99], v[84:87], v[152:155]
    ds_read_b64_tr_b16 v[52:53], v11 offset:0
    v_mfma_f32_16x16x32_bf16 v[156:159], v[96:99], v[88:91], v[156:159]
    ds_read_b64_tr_b16 v[54:55], v11 offset:1024
    s_add_u32 m0, s33, 34816
    s_add_u32 s34, s31, 57344
    buffer_load_dwordx4 v7, s[8:11], s34 offen lds
    v_mfma_f32_16x16x32_bf16 v[160:163], v[100:103], v[76:79], v[160:163]
    ds_read_b64_tr_b16 v[56:57], v12 offset:0
    v_mfma_f32_16x16x32_bf16 v[164:167], v[100:103], v[80:83], v[164:167]
    ds_read_b64_tr_b16 v[58:59], v12 offset:1024
    v_mfma_f32_16x16x32_bf16 v[168:171], v[100:103], v[84:87], v[168:171]
    ds_read_b64_tr_b16 v[60:61], v13 offset:0
    s_add_u32 m0, s33, 35840
    s_add_u32 s34, s31, 86016
    buffer_load_dwordx4 v7, s[8:11], s34 offen lds
    s_add_u32 s31, s31, 458752
    v_mfma_f32_16x16x32_bf16 v[172:175], v[100:103], v[88:91], v[172:175]
    ds_read_b64_tr_b16 v[62:63], v13 offset:1024
    v_mfma_f32_16x16x32_bf16 v[176:179], v[104:107], v[76:79], v[176:179]
    ds_read_b64_tr_b16 v[64:65], v14 offset:0
    v_mfma_f32_16x16x32_bf16 v[180:183], v[104:107], v[80:83], v[180:183]
    ds_read_b64_tr_b16 v[66:67], v14 offset:1024
    v_mfma_f32_16x16x32_bf16 v[184:187], v[104:107], v[84:87], v[184:187]
    ds_read_b64_tr_b16 v[68:69], v15 offset:0
    v_mfma_f32_16x16x32_bf16 v[188:191], v[104:107], v[88:91], v[188:191]
    ds_read_b64_tr_b16 v[70:71], v15 offset:1024
    v_mfma_f32_16x16x32_bf16 v[192:195], v[108:111], v[76:79], v[192:195]
    ds_read_b64_tr_b16 v[72:73], v16 offset:0
    v_mfma_f32_16x16x32_bf16 v[196:199], v[108:111], v[80:83], v[196:199]
    ds_read_b64_tr_b16 v[74:75], v16 offset:1024
    v_mfma_f32_16x16x32_bf16 v[200:203], v[108:111], v[84:87], v[200:203]
    v_mfma_f32_16x16x32_bf16 v[204:207], v[108:111], v[88:91], v[204:207]
    v_mfma_f32_16x16x32_bf16 v[208:211], v[112:115], v[76:79], v[208:211]
    v_mfma_f32_16x16x32_bf16 v[212:215], v[112:115], v[80:83], v[212:215]
    v_mfma_f32_16x16x32_bf16 v[216:219], v[112:115], v[84:87], v[216:219]
    v_mfma_f32_16x16x32_bf16 v[220:223], v[112:115], v[88:91], v[220:223]
    v_mfma_f32_16x16x32_bf16 v[224:227], v[116:119], v[76:79], v[224:227]
    v_mfma_f32_16x16x32_bf16 v[228:231], v[116:119], v[80:83], v[228:231]
    v_mfma_f32_16x16x32_bf16 v[232:235], v[116:119], v[84:87], v[232:235]
    v_mfma_f32_16x16x32_bf16 v[236:239], v[116:119], v[88:91], v[236:239]
    s_waitcnt lgkmcnt(0)
    v_mfma_f32_16x16x32_bf16 v[128:131], v[48:51], v[32:35], v[128:131]
    ds_read_b128 v[76:79], v9 offset:0
    v_mfma_f32_16x16x32_bf16 v[132:135], v[48:51], v[36:39], v[132:135]
    ds_read_b128 v[80:83], v9 offset:2048
    v_mfma_f32_16x16x32_bf16 v[136:139], v[48:51], v[40:43], v[136:139]
    ds_read_b128 v[84:87], v9 offset:4096
    v_mfma_f32_16x16x32_bf16 v[140:143], v[48:51], v[44:47], v[140:143]
    ds_read_b128 v[88:91], v9 offset:6144
    s_add_u32 s39, s39, 32768
    s_cmp_ge_u32 s39, 98304
    s_cselect_b32 s39, 0, s39
    v_add_u32 v9, s39, v19
    v_mfma_f32_16x16x32_bf16 v[144:147], v[52:55], v[32:35], v[144:147]
    ds_read_b64_tr_b16 v[92:93], v10 offset:8192
    v_mfma_f32_16x16x32_bf16 v[148:151], v[52:55], v[36:39], v[148:151]
    ds_read_b64_tr_b16 v[94:95], v10 offset:9216
    v_mfma_f32_16x16x32_bf16 v[152:155], v[52:55], v[40:43], v[152:155]
    ds_read_b64_tr_b16 v[96:97], v11 offset:8192
    v_mfma_f32_16x16x32_bf16 v[156:159], v[52:55], v[44:47], v[156:159]
    ds_read_b64_tr_b16 v[98:99], v11 offset:9216
    v_mfma_f32_16x16x32_bf16 v[160:163], v[56:59], v[32:35], v[160:163]
    ds_read_b64_tr_b16 v[100:101], v12 offset:8192
    v_mfma_f32_16x16x32_bf16 v[164:167], v[56:59], v[36:39], v[164:167]
    ds_read_b64_tr_b16 v[102:103], v12 offset:9216
    v_mfma_f32_16x16x32_bf16 v[168:171], v[56:59], v[40:43], v[168:171]
    ds_read_b64_tr_b16 v[104:105], v13 offset:8192
    v_mfma_f32_16x16x32_bf16 v[172:175], v[56:59], v[44:47], v[172:175]
    ds_read_b64_tr_b16 v[106:107], v13 offset:9216
    v_mfma_f32_16x16x32_bf16 v[176:179], v[60:63], v[32:35], v[176:179]
    ds_read_b64_tr_b16 v[108:109], v14 offset:8192
    v_mfma_f32_16x16x32_bf16 v[180:183], v[60:63], v[36:39], v[180:183]
    ds_read_b64_tr_b16 v[110:111], v14 offset:9216
    v_mfma_f32_16x16x32_bf16 v[184:187], v[60:63], v[40:43], v[184:187]
    ds_read_b64_tr_b16 v[112:113], v15 offset:8192
    v_mfma_f32_16x16x32_bf16 v[188:191], v[60:63], v[44:47], v[188:191]
    ds_read_b64_tr_b16 v[114:115], v15 offset:9216
    v_mfma_f32_16x16x32_bf16 v[192:195], v[64:67], v[32:35], v[192:195]
    ds_read_b64_tr_b16 v[116:117], v16 offset:8192
    v_mfma_f32_16x16x32_bf16 v[196:199], v[64:67], v[36:39], v[196:199]
    ds_read_b64_tr_b16 v[118:119], v16 offset:9216
    v_mfma_f32_16x16x32_bf16 v[200:203], v[64:67], v[40:43], v[200:203]
    v_mfma_f32_16x16x32_bf16 v[204:207], v[64:67], v[44:47], v[204:207]
    v_mfma_f32_16x16x32_bf16 v[208:211], v[68:71], v[32:35], v[208:211]
    v_mfma_f32_16x16x32_bf16 v[212:215], v[68:71], v[36:39], v[212:215]
    v_mfma_f32_16x16x32_bf16 v[216:219], v[68:71], v[40:43], v[216:219]
    v_mfma_f32_16x16x32_bf16 v[220:223], v[68:71], v[44:47], v[220:223]
    v_mfma_f32_16x16x32_bf16 v[224:227], v[72:75], v[32:35], v[224:227]
    v_mfma_f32_16x16x32_bf16 v[228:231], v[72:75], v[36:39], v[228:231]
    v_mfma_f32_16x16x32_bf16 v[232:235], v[72:75], v[40:43], v[232:235]
    v_mfma_f32_16x16x32_bf16 v[236:239], v[72:75], v[44:47], v[236:239]
    s_waitcnt vmcnt(0) lgkmcnt(0)
    s_barrier
    v_mfma_f32_16x16x32_bf16 v[128:131], v[92:95], v[76:79], v[128:131]
    ds_read_b128 v[32:35], v8 offset:0
    v_mfma_f32_16x16x32_bf16 v[132:135], v[92:95], v[80:83], v[132:135]
    ds_read_b128 v[36:39], v8 offset:2048
    v_mfma_f32_16x16x32_bf16 v[136:139], v[92:95], v[84:87], v[136:139]
    ds_read_b128 v[40:43], v8 offset:4096
    v_mfma_f32_16x16x32_bf16 v[140:143], v[92:95], v[88:91], v[140:143]
    ds_read_b128 v[44:47], v8 offset:6144
    s_add_u32 s38, s38, 32768
    s_cmp_ge_u32 s38, 98304
    s_cselect_b32 s38, 0, s38
    v_add_u32 v8, s38, v18
    v_mfma_f32_16x16x32_bf16 v[144:147], v[96:99], v[76:79], v[144:147]
    ds_read_b64_tr_b16 v[48:49], v10 offset:32768
    v_mfma_f32_16x16x32_bf16 v[148:151], v[96:99], v[80:83], v[148:151]
    ds_read_b64_tr_b16 v[50:51], v10 offset:33792
    v_mfma_f32_16x16x32_bf16 v[152:155], v[96:99], v[84:87], v[152:155]
    ds_read_b64_tr_b16 v[52:53], v11 offset:32768
    v_mfma_f32_16x16x32_bf16 v[156:159], v[96:99], v[88:91], v[156:159]
    ds_read_b64_tr_b16 v[54:55], v11 offset:33792
    v_mfma_f32_16x16x32_bf16 v[160:163], v[100:103], v[76:79], v[160:163]
    ds_read_b64_tr_b16 v[56:57], v12 offset:32768
    v_mfma_f32_16x16x32_bf16 v[164:167], v[100:103], v[80:83], v[164:167]
    ds_read_b64_tr_b16 v[58:59], v12 offset:33792
    v_mfma_f32_16x16x32_bf16 v[168:171], v[100:103], v[84:87], v[168:171]
    ds_read_b64_tr_b16 v[60:61], v13 offset:32768
    v_mfma_f32_16x16x32_bf16 v[172:175], v[100:103], v[88:91], v[172:175]
    ds_read_b64_tr_b16 v[62:63], v13 offset:33792
    v_mfma_f32_16x16x32_bf16 v[176:179], v[104:107], v[76:79], v[176:179]
    ds_read_b64_tr_b16 v[64:65], v14 offset:32768
    v_mfma_f32_16x16x32_bf16 v[180:183], v[104:107], v[80:83], v[180:183]
    ds_read_b64_tr_b16 v[66:67], v14 offset:33792
    v_mfma_f32_16x16x32_bf16 v[184:187], v[104:107], v[84:87], v[184:187]
    ds_read_b64_tr_b16 v[68:69], v15 offset:32768
    v_mfma_f32_16x16x32_bf16 v[188:191], v[104:107], v[88:91], v[188:191]
    ds_read_b64_tr_b16 v[70:71], v15 offset:33792
    v_mfma_f32_16x16x32_bf16 v[192:195], v[108:111], v[76:79], v[192:195]
    ds_read_b64_tr_b16 v[72:73], v16 offset:32768
    v_mfma_f32_16x16x32_bf16 v[196:199], v[108:111], v[80:83], v[196:199]
    ds_read_b64_tr_b16 v[74:75], v16 offset:33792
    v_mfma_f32_16x16x32_bf16 v[200:203], v[108:111], v[84:87], v[200:203]
    v_mfma_f32_16x16x32_bf16 v[204:207], v[108:111], v[88:91], v[204:207]
    v_mfma_f32_16x16x32_bf16 v[208:211], v[112:115], v[76:79], v[208:211]
    v_mfma_f32_16x16x32_bf16 v[212:215], v[112:115], v[80:83], v[212:215]
    v_mfma_f32_16x16x32_bf16 v[216:219], v[112:115], v[84:87], v[216:219]
    v_mfma_f32_16x16x32_bf16 v[220:223], v[112:115], v[88:91], v[220:223]
    v_mfma_f32_16x16x32_bf16 v[224:227], v[116:119], v[76:79], v[224:227]
    v_mfma_f32_16x16x32_bf16 v[228:231], v[116:119], v[80:83], v[228:231]
    v_mfma_f32_16x16x32_bf16 v[232:235], v[116:119], v[84:87], v[232:235]
    v_mfma_f32_16x16x32_bf16 v[236:239], v[116:119], v[88:91], v[236:239]
    s_waitcnt lgkmcnt(0)
    v_mfma_f32_16x16x32_bf16 v[128:131], v[48:51], v[32:35], v[128:131]
    ds_read_b128 v[76:79], v9 offset:0
    v_mfma_f32_16x16x32_bf16 v[132:135], v[48:51], v[36:39], v[132:135]
    ds_read_b128 v[80:83], v9 offset:2048
    v_mfma_f32_16x16x32_bf16 v[136:139], v[48:51], v[40:43], v[136:139]
    ds_read_b128 v[84:87], v9 offset:4096
    v_mfma_f32_16x16x32_bf16 v[140:143], v[48:51], v[44:47], v[140:143]
    ds_read_b128 v[88:91], v9 offset:6144
    s_add_u32 s39, s39, 32768
    s_cmp_ge_u32 s39, 98304
    s_cselect_b32 s39, 0, s39
    v_add_u32 v9, s39, v19
    v_mfma_f32_16x16x32_bf16 v[144:147], v[52:55], v[32:35], v[144:147]
    ds_read_b64_tr_b16 v[92:93], v10 offset:40960
    v_mfma_f32_16x16x32_bf16 v[148:151], v[52:55], v[36:39], v[148:151]
    ds_read_b64_tr_b16 v[94:95], v10 offset:41984
    v_mfma_f32_16x16x32_bf16 v[152:155], v[52:55], v[40:43], v[152:155]
    ds_read_b64_tr_b16 v[96:97], v11 offset:40960
    v_mfma_f32_16x16x32_bf16 v[156:159], v[52:55], v[44:47], v[156:159]
    ds_read_b64_tr_b16 v[98:99], v11 offset:41984
    v_mfma_f32_16x16x32_bf16 v[160:163], v[56:59], v[32:35], v[160:163]
    ds_read_b64_tr_b16 v[100:101], v12 offset:40960
    v_mfma_f32_16x16x32_bf16 v[164:167], v[56:59], v[36:39], v[164:167]
    ds_read_b64_tr_b16 v[102:103], v12 offset:41984
    v_mfma_f32_16x16x32_bf16 v[168:171], v[56:59], v[40:43], v[168:171]
    ds_read_b64_tr_b16 v[104:105], v13 offset:40960
    v_mfma_f32_16x16x32_bf16 v[172:175], v[56:59], v[44:47], v[172:175]
    ds_read_b64_tr_b16 v[106:107], v13 offset:41984
    v_mfma_f32_16x16x32_bf16 v[176:179], v[60:63], v[32:35], v[176:179]
    ds_read_b64_tr_b16 v[108:109], v14 offset:40960
    v_mfma_f32_16x16x32_bf16 v[180:183], v[60:63], v[36:39], v[180:183]
    ds_read_b64_tr_b16 v[110:111], v14 offset:41984
    v_mfma_f32_16x16x32_bf16 v[184:187], v[60:63], v[40:43], v[184:187]
    ds_read_b64_tr_b16 v[112:113], v15 offset:40960
    v_mfma_f32_16x16x32_bf16 v[188:191], v[60:63], v[44:47], v[188:191]
    ds_read_b64_tr_b16 v[114:115], v15 offset:41984
    v_mfma_f32_16x16x32_bf16 v[192:195], v[64:67], v[32:35], v[192:195]
    ds_read_b64_tr_b16 v[116:117], v16 offset:40960
    v_mfma_f32_16x16x32_bf16 v[196:199], v[64:67], v[36:39], v[196:199]
    ds_read_b64_tr_b16 v[118:119], v16 offset:41984
    v_mfma_f32_16x16x32_bf16 v[200:203], v[64:67], v[40:43], v[200:203]
    v_mfma_f32_16x16x32_bf16 v[204:207], v[64:67], v[44:47], v[204:207]
    v_mfma_f32_16x16x32_bf16 v[208:211], v[68:71], v[32:35], v[208:211]
    v_mfma_f32_16x16x32_bf16 v[212:215], v[68:71], v[36:39], v[212:215]
    v_mfma_f32_16x16x32_bf16 v[216:219], v[68:71], v[40:43], v[216:219]
    v_mfma_f32_16x16x32_bf16 v[220:223], v[68:71], v[44:47], v[220:223]
    v_mfma_f32_16x16x32_bf16 v[224:227], v[72:75], v[32:35], v[224:227]
    v_mfma_f32_16x16x32_bf16 v[228:231], v[72:75], v[36:39], v[228:231]
    v_mfma_f32_16x16x32_bf16 v[232:235], v[72:75], v[40:43], v[232:235]
    v_mfma_f32_16x16x32_bf16 v[236:239], v[72:75], v[44:47], v[236:239]
    s_waitcnt vmcnt(0) lgkmcnt(0)
    s_barrier
    v_mfma_f32_16x16x32_bf16 v[128:131], v[92:95], v[76:79], v[128:131]
    v_mfma_f32_16x16x32_bf16 v[132:135], v[92:95], v[80:83], v[132:135]
    v_mfma_f32_16x16x32_bf16 v[136:139], v[92:95], v[84:87], v[136:139]
    v_mfma_f32_16x16x32_bf16 v[140:143], v[92:95], v[88:91], v[140:143]
    v_mfma_f32_16x16x32_bf16 v[144:147], v[96:99], v[76:79], v[144:147]
    v_mfma_f32_16x16x32_bf16 v[148:151], v[96:99], v[80:83], v[148:151]
    v_mfma_f32_16x16x32_bf16 v[152:155], v[96:99], v[84:87], v[152:155]
    v_mfma_f32_16x16x32_bf16 v[156:159], v[96:99], v[88:91], v[156:159]
    v_mfma_f32_16x16x32_bf16 v[160:163], v[100:103], v[76:79], v[160:163]
    v_mfma_f32_16x16x32_bf16 v[164:167], v[100:103], v[80:83], v[164:167]
    v_mfma_f32_16x16x32_bf16 v[168:171], v[100:103], v[84:87], v[168:171]
    v_mfma_f32_16x16x32_bf16 v[172:175], v[100:103], v[88:91], v[172:175]
    v_mfma_f32_16x16x32_bf16 v[176:179], v[104:107], v[76:79], v[176:179]
    v_mfma_f32_16x16x32_bf16 v[180:183], v[104:107], v[80:83], v[180:183]
    v_mfma_f32_16x16x32_bf16 v[184:187], v[104:107], v[84:87], v[184:187]
    v_mfma_f32_16x16x32_bf16 v[188:191], v[104:107], v[88:91], v[188:191]
    v_mfma_f32_16x16x32_bf16 v[192:195], v[108:111], v[76:79], v[192:195]
    v_mfma_f32_16x16x32_bf16 v[196:199], v[108:111], v[80:83], v[196:199]
    v_mfma_f32_16x16x32_bf16 v[200:203], v[108:111], v[84:87], v[200:203]
    v_mfma_f32_16x16x32_bf16 v[204:207], v[108:111], v[88:91], v[204:207]
    v_mfma_f32_16x16x32_bf16 v[208:211], v[112:115], v[76:79], v[208:211]
    v_mfma_f32_16x16x32_bf16 v[212:215], v[112:115], v[80:83], v[212:215]
    v_mfma_f32_16x16x32_bf16 v[216:219], v[112:115], v[84:87], v[216:219]
    v_mfma_f32_16x16x32_bf16 v[220:223], v[112:115], v[88:91], v[220:223]
    v_mfma_f32_16x16x32_bf16 v[224:227], v[116:119], v[76:79], v[224:227]
    v_mfma_f32_16x16x32_bf16 v[228:231], v[116:119], v[80:83], v[228:231]
    v_mfma_f32_16x16x32_bf16 v[232:235], v[116:119], v[84:87], v[232:235]
    v_mfma_f32_16x16x32_bf16 v[236:239], v[116:119], v[88:91], v[236:239]
    s_mov_b32 s48, s44
    s_mov_b32 s49, s45
    s_mov_b32 s50, 0x700000
    s_mov_b32 s51, 0x00020000
    v_lshlrev_b32 v24, 7, v0
    v_cmp_gt_u32 vcc, 224, v0
    v_mov_b32 v25, 0x80000000
    s_mul_i32 s21, s2, 28672
    v_cndmask_b32 v24, v25, v24, vcc
    buffer_load_dword v30, v24, s[48:51], s21 offen
    s_nop 3
    v_lshlrev_b32 v24, 4, v2
    s_lshl_b32 s21, s18, 11
    v_add_u32 v25, s21, v24
    s_xor_b32 s21, s18, 4
    s_lshl_b32 s21, s21, 11
    v_add_u32 v26, s21, v24
    s_cmp_eq_u32 s20, 0
    s_cbranch_scc0 Lg1_x1
    ds_write_b128 v25, v[184:187]
    ds_write_b128 v25, v[188:191] offset:1024
    s_branch Lg1_x2
Lg1_x1:
    ds_write_b128 v25, v[176:179]
    ds_write_b128 v25, v[180:183] offset:1024
Lg1_x2:
    s_waitcnt lgkmcnt(0)
    s_barrier
    ds_read_b128 v[32:35], v26
    ds_read_b128 v[36:39], v26 offset:1024
    v_and_b32 v24, 1, v20
    v_lshl_add_u32 v24, v24, 4, v21
    v_lshlrev_b32 v24, 5, v24
    v_lshrrev_b32 v25, 1, v20
    v_lshl_add_u32 v27, v25, 4, v24
    s_mul_i32 s21, s17, 224
    s_mul_i32 s22, s16, 7
    s_add_u32 s21, s21, s22
    s_lshl_b32 s21, s21, 13
    s_lshl_b32 s22, s19, 11
    s_add_u32 s21, s21, s22
    s_lshl_b32 s22, s20, 15
    s_add_u32 s22, s22, s21
    v_cvt_pk_bf16_f32 v40, v128, v129
    v_lshlrev_b32 v128, 16, v40
    v_and_b32 v129, 0xffff0000, v40
    v_cvt_pk_bf16_f32 v41, v130, v131
    v_lshlrev_b32 v130, 16, v41
    v_and_b32 v131, 0xffff0000, v41
    v_cvt_pk_bf16_f32 v42, v192, v193
    v_lshlrev_b32 v192, 16, v42
    v_and_b32 v193, 0xffff0000, v42
    v_cvt_pk_bf16_f32 v43, v194, v195
    v_lshlrev_b32 v194, 16, v43
    v_and_b32 v195, 0xffff0000, v43
    v_pk_mul_f32 v[40:41], v[128:129], s[40:41]
    v_pk_mul_f32 v[42:43], v[130:131], s[40:41]
    v_exp_f32 v40, v40
    v_exp_f32 v41, v41
    v_exp_f32 v42, v42
    v_exp_f32 v43, v43
    s_nop 0
    v_pk_add_f32 v[40:41], v[40:41], s[42:43]
    v_pk_add_f32 v[42:43], v[42:43], s[42:43]
    v_rcp_f32 v40, v40
    v_rcp_f32 v41, v41
    v_rcp_f32 v42, v42
    v_rcp_f32 v43, v43
    s_nop 0
    v_pk_mul_f32 v[128:129], v[128:129], v[40:41]
    v_pk_mul_f32 v[130:131], v[130:131], v[42:43]
    v_cvt_pk_bf16_f32 v40, v128, v129
    v_lshlrev_b32 v128, 16, v40
    v_and_b32 v129, 0xffff0000, v40
    v_cvt_pk_bf16_f32 v41, v130, v131
    v_lshlrev_b32 v130, 16, v41
    v_and_b32 v131, 0xffff0000, v41
    v_pk_mul_f32 v[128:129], v[128:129], v[192:193]
    v_pk_mul_f32 v[130:131], v[130:131], v[194:195]
    v_cvt_pk_bf16_f32 v60, v128, v129
    v_cvt_pk_bf16_f32 v61, v130, v131
    v_cvt_pk_bf16_f32 v44, v132, v133
    v_lshlrev_b32 v132, 16, v44
    v_and_b32 v133, 0xffff0000, v44
    v_cvt_pk_bf16_f32 v45, v134, v135
    v_lshlrev_b32 v134, 16, v45
    v_and_b32 v135, 0xffff0000, v45
    v_cvt_pk_bf16_f32 v46, v196, v197
    v_lshlrev_b32 v196, 16, v46
    v_and_b32 v197, 0xffff0000, v46
    v_cvt_pk_bf16_f32 v47, v198, v199
    v_lshlrev_b32 v198, 16, v47
    v_and_b32 v199, 0xffff0000, v47
    v_pk_mul_f32 v[44:45], v[132:133], s[40:41]
    v_pk_mul_f32 v[46:47], v[134:135], s[40:41]
    v_exp_f32 v44, v44
    v_exp_f32 v45, v45
    v_exp_f32 v46, v46
    v_exp_f32 v47, v47
    s_nop 0
    v_pk_add_f32 v[44:45], v[44:45], s[42:43]
    v_pk_add_f32 v[46:47], v[46:47], s[42:43]
    v_rcp_f32 v44, v44
    v_rcp_f32 v45, v45
    v_rcp_f32 v46, v46
    v_rcp_f32 v47, v47
    s_nop 0
    v_pk_mul_f32 v[132:133], v[132:133], v[44:45]
    v_pk_mul_f32 v[134:135], v[134:135], v[46:47]
    v_cvt_pk_bf16_f32 v44, v132, v133
    v_lshlrev_b32 v132, 16, v44
    v_and_b32 v133, 0xffff0000, v44
    v_cvt_pk_bf16_f32 v45, v134, v135
    v_lshlrev_b32 v134, 16, v45
    v_and_b32 v135, 0xffff0000, v45
    v_pk_mul_f32 v[132:133], v[132:133], v[196:197]
    v_pk_mul_f32 v[134:135], v[134:135], v[198:199]
    v_cvt_pk_bf16_f32 v62, v132, v133
    v_cvt_pk_bf16_f32 v63, v134, v135
    s_add_u32 s23, s22, 0
    s_nop 0
    v_permlane16_swap_b32 v60, v62
    v_permlane16_swap_b32 v61, v63
    buffer_store_dwordx4 v[60:63], v27, s[12:15], s23 offen
    v_cvt_pk_bf16_f32 v48, v136, v137
    v_lshlrev_b32 v136, 16, v48
    v_and_b32 v137, 0xffff0000, v48
    v_cvt_pk_bf16_f32 v49, v138, v139
    v_lshlrev_b32 v138, 16, v49
    v_and_b32 v139, 0xffff0000, v49
    v_cvt_pk_bf16_f32 v50, v200, v201
    v_lshlrev_b32 v200, 16, v50
    v_and_b32 v201, 0xffff0000, v50
    v_cvt_pk_bf16_f32 v51, v202, v203
    v_lshlrev_b32 v202, 16, v51
    v_and_b32 v203, 0xffff0000, v51
    v_pk_mul_f32 v[48:49], v[136:137], s[40:41]
    v_pk_mul_f32 v[50:51], v[138:139], s[40:41]
    v_exp_f32 v48, v48
    v_exp_f32 v49, v49
    v_exp_f32 v50, v50
    v_exp_f32 v51, v51
    s_nop 0
    v_pk_add_f32 v[48:49], v[48:49], s[42:43]
    v_pk_add_f32 v[50:51], v[50:51], s[42:43]
    v_rcp_f32 v48, v48
    v_rcp_f32 v49, v49
    v_rcp_f32 v50, v50
    v_rcp_f32 v51, v51
    s_nop 0
    v_pk_mul_f32 v[136:137], v[136:137], v[48:49]
    v_pk_mul_f32 v[138:139], v[138:139], v[50:51]
    v_cvt_pk_bf16_f32 v48, v136, v137
    v_lshlrev_b32 v136, 16, v48
    v_and_b32 v137, 0xffff0000, v48
    v_cvt_pk_bf16_f32 v49, v138, v139
    v_lshlrev_b32 v138, 16, v49
    v_and_b32 v139, 0xffff0000, v49
    v_pk_mul_f32 v[136:137], v[136:137], v[200:201]
    v_pk_mul_f32 v[138:139], v[138:139], v[202:203]
    v_cvt_pk_bf16_f32 v64, v136, v137
    v_cvt_pk_bf16_f32 v65, v138, v139
    v_cvt_pk_bf16_f32 v52, v140, v141
    v_lshlrev_b32 v140, 16, v52
    v_and_b32 v141, 0xffff0000, v52
    v_cvt_pk_bf16_f32 v53, v142, v143
    v_lshlrev_b32 v142, 16, v53
    v_and_b32 v143, 0xffff0000, v53
    v_cvt_pk_bf16_f32 v54, v204, v205
    v_lshlrev_b32 v204, 16, v54
    v_and_b32 v205, 0xffff0000, v54
    v_cvt_pk_bf16_f32 v55, v206, v207
    v_lshlrev_b32 v206, 16, v55
    v_and_b32 v207, 0xffff0000, v55
    v_pk_mul_f32 v[52:53], v[140:141], s[40:41]
    v_pk_mul_f32 v[54:55], v[142:143], s[40:41]
    v_exp_f32 v52, v52
    v_exp_f32 v53, v53
    v_exp_f32 v54, v54
    v_exp_f32 v55, v55
    s_nop 0
    v_pk_add_f32 v[52:53], v[52:53], s[42:43]
    v_pk_add_f32 v[54:55], v[54:55], s[42:43]
    v_rcp_f32 v52, v52
    v_rcp_f32 v53, v53
    v_rcp_f32 v54, v54
    v_rcp_f32 v55, v55
    s_nop 0
    v_pk_mul_f32 v[140:141], v[140:141], v[52:53]
    v_pk_mul_f32 v[142:143], v[142:143], v[54:55]
    v_cvt_pk_bf16_f32 v52, v140, v141
    v_lshlrev_b32 v140, 16, v52
    v_and_b32 v141, 0xffff0000, v52
    v_cvt_pk_bf16_f32 v53, v142, v143
    v_lshlrev_b32 v142, 16, v53
    v_and_b32 v143, 0xffff0000, v53
    v_pk_mul_f32 v[140:141], v[140:141], v[204:205]
    v_pk_mul_f32 v[142:143], v[142:143], v[206:207]
    v_cvt_pk_bf16_f32 v66, v140, v141
    v_cvt_pk_bf16_f32 v67, v142, v143
    s_add_u32 s23, s22, 1024
    s_nop 0
    v_permlane16_swap_b32 v64, v66
    v_permlane16_swap_b32 v65, v67
    buffer_store_dwordx4 v[64:67], v27, s[12:15], s23 offen
    v_cvt_pk_bf16_f32 v40, v144, v145
    v_lshlrev_b32 v144, 16, v40
    v_and_b32 v145, 0xffff0000, v40
    v_cvt_pk_bf16_f32 v41, v146, v147
    v_lshlrev_b32 v146, 16, v41
    v_and_b32 v147, 0xffff0000, v41
    v_cvt_pk_bf16_f32 v42, v208, v209
    v_lshlrev_b32 v208, 16, v42
    v_and_b32 v209, 0xffff0000, v42
    v_cvt_pk_bf16_f32 v43, v210, v211
    v_lshlrev_b32 v210, 16, v43
    v_and_b32 v211, 0xffff0000, v43
    v_pk_mul_f32 v[40:41], v[144:145], s[40:41]
    v_pk_mul_f32 v[42:43], v[146:147], s[40:41]
    v_exp_f32 v40, v40
    v_exp_f32 v41, v41
    v_exp_f32 v42, v42
    v_exp_f32 v43, v43
    s_nop 0
    v_pk_add_f32 v[40:41], v[40:41], s[42:43]
    v_pk_add_f32 v[42:43], v[42:43], s[42:43]
    v_rcp_f32 v40, v40
    v_rcp_f32 v41, v41
    v_rcp_f32 v42, v42
    v_rcp_f32 v43, v43
    s_nop 0
    v_pk_mul_f32 v[144:145], v[144:145], v[40:41]
    v_pk_mul_f32 v[146:147], v[146:147], v[42:43]
    v_cvt_pk_bf16_f32 v40, v144, v145
    v_lshlrev_b32 v144, 16, v40
    v_and_b32 v145, 0xffff0000, v40
    v_cvt_pk_bf16_f32 v41, v146, v147
    v_lshlrev_b32 v146, 16, v41
    v_and_b32 v147, 0xffff0000, v41
    v_pk_mul_f32 v[144:145], v[144:145], v[208:209]
    v_pk_mul_f32 v[146:147], v[146:147], v[210:211]
    v_cvt_pk_bf16_f32 v68, v144, v145
    v_cvt_pk_bf16_f32 v69, v146, v147
    v_cvt_pk_bf16_f32 v44, v148, v149
    v_lshlrev_b32 v148, 16, v44
    v_and_b32 v149, 0xffff0000, v44
    v_cvt_pk_bf16_f32 v45, v150, v151
    v_lshlrev_b32 v150, 16, v45
    v_and_b32 v151, 0xffff0000, v45
    v_cvt_pk_bf16_f32 v46, v212, v213
    v_lshlrev_b32 v212, 16, v46
    v_and_b32 v213, 0xffff0000, v46
    v_cvt_pk_bf16_f32 v47, v214, v215
    v_lshlrev_b32 v214, 16, v47
    v_and_b32 v215, 0xffff0000, v47
    v_pk_mul_f32 v[44:45], v[148:149], s[40:41]
    v_pk_mul_f32 v[46:47], v[150:151], s[40:41]
    v_exp_f32 v44, v44
    v_exp_f32 v45, v45
    v_exp_f32 v46, v46
    v_exp_f32 v47, v47
    s_nop 0
    v_pk_add_f32 v[44:45], v[44:45], s[42:43]
    v_pk_add_f32 v[46:47], v[46:47], s[42:43]
    v_rcp_f32 v44, v44
    v_rcp_f32 v45, v45
    v_rcp_f32 v46, v46
    v_rcp_f32 v47, v47
    s_nop 0
    v_pk_mul_f32 v[148:149], v[148:149], v[44:45]
    v_pk_mul_f32 v[150:151], v[150:151], v[46:47]
    v_cvt_pk_bf16_f32 v44, v148, v149
    v_lshlrev_b32 v148, 16, v44
    v_and_b32 v149, 0xffff0000, v44
    v_cvt_pk_bf16_f32 v45, v150, v151
    v_lshlrev_b32 v150, 16, v45
    v_and_b32 v151, 0xffff0000, v45
    v_pk_mul_f32 v[148:149], v[148:149], v[212:213]
    v_pk_mul_f32 v[150:151], v[150:151], v[214:215]
    v_cvt_pk_bf16_f32 v70, v148, v149
    v_cvt_pk_bf16_f32 v71, v150, v151
    s_add_u32 s23, s22, 8192
    s_nop 0
    v_permlane16_swap_b32 v68, v70
    v_permlane16_swap_b32 v69, v71
    buffer_store_dwordx4 v[68:71], v27, s[12:15], s23 offen
    v_cvt_pk_bf16_f32 v48, v152, v153
    v_lshlrev_b32 v152, 16, v48
    v_and_b32 v153, 0xffff0000, v48
    v_cvt_pk_bf16_f32 v49, v154, v155
    v_lshlrev_b32 v154, 16, v49
    v_and_b32 v155, 0xffff0000, v49
    v_cvt_pk_bf16_f32 v50, v216, v217
    v_lshlrev_b32 v216, 16, v50
    v_and_b32 v217, 0xffff0000, v50
    v_cvt_pk_bf16_f32 v51, v218, v219
    v_lshlrev_b32 v218, 16, v51
    v_and_b32 v219, 0xffff0000, v51
    v_pk_mul_f32 v[48:49], v[152:153], s[40:41]
    v_pk_mul_f32 v[50:51], v[154:155], s[40:41]
    v_exp_f32 v48, v48
    v_exp_f32 v49, v49
    v_exp_f32 v50, v50
    v_exp_f32 v51, v51
    s_nop 0
    v_pk_add_f32 v[48:49], v[48:49], s[42:43]
    v_pk_add_f32 v[50:51], v[50:51], s[42:43]
    v_rcp_f32 v48, v48
    v_rcp_f32 v49, v49
    v_rcp_f32 v50, v50
    v_rcp_f32 v51, v51
    s_nop 0
    v_pk_mul_f32 v[152:153], v[152:153], v[48:49]
    v_pk_mul_f32 v[154:155], v[154:155], v[50:51]
    v_cvt_pk_bf16_f32 v48, v152, v153
    v_lshlrev_b32 v152, 16, v48
    v_and_b32 v153, 0xffff0000, v48
    v_cvt_pk_bf16_f32 v49, v154, v155
    v_lshlrev_b32 v154, 16, v49
    v_and_b32 v155, 0xffff0000, v49
    v_pk_mul_f32 v[152:153], v[152:153], v[216:217]
    v_pk_mul_f32 v[154:155], v[154:155], v[218:219]
    v_cvt_pk_bf16_f32 v72, v152, v153
    v_cvt_pk_bf16_f32 v73, v154, v155
    v_cvt_pk_bf16_f32 v52, v156, v157
    v_lshlrev_b32 v156, 16, v52
    v_and_b32 v157, 0xffff0000, v52
    v_cvt_pk_bf16_f32 v53, v158, v159
    v_lshlrev_b32 v158, 16, v53
    v_and_b32 v159, 0xffff0000, v53
    v_cvt_pk_bf16_f32 v54, v220, v221
    v_lshlrev_b32 v220, 16, v54
    v_and_b32 v221, 0xffff0000, v54
    v_cvt_pk_bf16_f32 v55, v222, v223
    v_lshlrev_b32 v222, 16, v55
    v_and_b32 v223, 0xffff0000, v55
    v_pk_mul_f32 v[52:53], v[156:157], s[40:41]
    v_pk_mul_f32 v[54:55], v[158:159], s[40:41]
    v_exp_f32 v52, v52
    v_exp_f32 v53, v53
    v_exp_f32 v54, v54
    v_exp_f32 v55, v55
    s_nop 0
    v_pk_add_f32 v[52:53], v[52:53], s[42:43]
    v_pk_add_f32 v[54:55], v[54:55], s[42:43]
    v_rcp_f32 v52, v52
    v_rcp_f32 v53, v53
    v_rcp_f32 v54, v54
    v_rcp_f32 v55, v55
    s_nop 0
    v_pk_mul_f32 v[156:157], v[156:157], v[52:53]
    v_pk_mul_f32 v[158:159], v[158:159], v[54:55]
    v_cvt_pk_bf16_f32 v52, v156, v157
    v_lshlrev_b32 v156, 16, v52
    v_and_b32 v157, 0xffff0000, v52
    v_cvt_pk_bf16_f32 v53, v158, v159
    v_lshlrev_b32 v158, 16, v53
    v_and_b32 v159, 0xffff0000, v53
    v_pk_mul_f32 v[156:157], v[156:157], v[220:221]
    v_pk_mul_f32 v[158:159], v[158:159], v[222:223]
    v_cvt_pk_bf16_f32 v74, v156, v157
    v_cvt_pk_bf16_f32 v75, v158, v159
    s_add_u32 s23, s22, 9216
    s_nop 0
    v_permlane16_swap_b32 v72, v74
    v_permlane16_swap_b32 v73, v75
    buffer_store_dwordx4 v[72:75], v27, s[12:15], s23 offen
    v_cvt_pk_bf16_f32 v40, v160, v161
    v_lshlrev_b32 v160, 16, v40
    v_and_b32 v161, 0xffff0000, v40
    v_cvt_pk_bf16_f32 v41, v162, v163
    v_lshlrev_b32 v162, 16, v41
    v_and_b32 v163, 0xffff0000, v41
    v_cvt_pk_bf16_f32 v42, v224, v225
    v_lshlrev_b32 v224, 16, v42
    v_and_b32 v225, 0xffff0000, v42
    v_cvt_pk_bf16_f32 v43, v226, v227
    v_lshlrev_b32 v226, 16, v43
    v_and_b32 v227, 0xffff0000, v43
    v_pk_mul_f32 v[40:41], v[160:161], s[40:41]
    v_pk_mul_f32 v[42:43], v[162:163], s[40:41]
    v_exp_f32 v40, v40
    v_exp_f32 v41, v41
    v_exp_f32 v42, v42
    v_exp_f32 v43, v43
    s_nop 0
    v_pk_add_f32 v[40:41], v[40:41], s[42:43]
    v_pk_add_f32 v[42:43], v[42:43], s[42:43]
    v_rcp_f32 v40, v40
    v_rcp_f32 v41, v41
    v_rcp_f32 v42, v42
    v_rcp_f32 v43, v43
    s_nop 0
    v_pk_mul_f32 v[160:161], v[160:161], v[40:41]
    v_pk_mul_f32 v[162:163], v[162:163], v[42:43]
    v_cvt_pk_bf16_f32 v40, v160, v161
    v_lshlrev_b32 v160, 16, v40
    v_and_b32 v161, 0xffff0000, v40
    v_cvt_pk_bf16_f32 v41, v162, v163
    v_lshlrev_b32 v162, 16, v41
    v_and_b32 v163, 0xffff0000, v41
    v_pk_mul_f32 v[160:161], v[160:161], v[224:225]
    v_pk_mul_f32 v[162:163], v[162:163], v[226:227]
    v_cvt_pk_bf16_f32 v60, v160, v161
    v_cvt_pk_bf16_f32 v61, v162, v163
    v_cvt_pk_bf16_f32 v44, v164, v165
    v_lshlrev_b32 v164, 16, v44
    v_and_b32 v165, 0xffff0000, v44
    v_cvt_pk_bf16_f32 v45, v166, v167
    v_lshlrev_b32 v166, 16, v45
    v_and_b32 v167, 0xffff0000, v45
    v_cvt_pk_bf16_f32 v46, v228, v229
    v_lshlrev_b32 v228, 16, v46
    v_and_b32 v229, 0xffff0000, v46
    v_cvt_pk_bf16_f32 v47, v230, v231
    v_lshlrev_b32 v230, 16, v47
    v_and_b32 v231, 0xffff0000, v47
    v_pk_mul_f32 v[44:45], v[164:165], s[40:41]
    v_pk_mul_f32 v[46:47], v[166:167], s[40:41]
    v_exp_f32 v44, v44
    v_exp_f32 v45, v45
    v_exp_f32 v46, v46
    v_exp_f32 v47, v47
    s_nop 0
    v_pk_add_f32 v[44:45], v[44:45], s[42:43]
    v_pk_add_f32 v[46:47], v[46:47], s[42:43]
    v_rcp_f32 v44, v44
    v_rcp_f32 v45, v45
    v_rcp_f32 v46, v46
    v_rcp_f32 v47, v47
    s_nop 0
    v_pk_mul_f32 v[164:165], v[164:165], v[44:45]
    v_pk_mul_f32 v[166:167], v[166:167], v[46:47]
    v_cvt_pk_bf16_f32 v44, v164, v165
    v_lshlrev_b32 v164, 16, v44
    v_and_b32 v165, 0xffff0000, v44
    v_cvt_pk_bf16_f32 v45, v166, v167
    v_lshlrev_b32 v166, 16, v45
    v_and_b32 v167, 0xffff0000, v45
    v_pk_mul_f32 v[164:165], v[164:165], v[228:229]
    v_pk_mul_f32 v[166:167], v[166:167], v[230:231]
    v_cvt_pk_bf16_f32 v62, v164, v165
    v_cvt_pk_bf16_f32 v63, v166, v167
    s_add_u32 s23, s22, 16384
    s_nop 0
    v_permlane16_swap_b32 v60, v62
    v_permlane16_swap_b32 v61, v63
    buffer_store_dwordx4 v[60:63], v27, s[12:15], s23 offen
    v_cvt_pk_bf16_f32 v48, v168, v169
    v_lshlrev_b32 v168, 16, v48
    v_and_b32 v169, 0xffff0000, v48
    v_cvt_pk_bf16_f32 v49, v170, v171
    v_lshlrev_b32 v170, 16, v49
    v_and_b32 v171, 0xffff0000, v49
    v_cvt_pk_bf16_f32 v50, v232, v233
    v_lshlrev_b32 v232, 16, v50
    v_and_b32 v233, 0xffff0000, v50
    v_cvt_pk_bf16_f32 v51, v234, v235
    v_lshlrev_b32 v234, 16, v51
    v_and_b32 v235, 0xffff0000, v51
    v_pk_mul_f32 v[48:49], v[168:169], s[40:41]
    v_pk_mul_f32 v[50:51], v[170:171], s[40:41]
    v_exp_f32 v48, v48
    v_exp_f32 v49, v49
    v_exp_f32 v50, v50
    v_exp_f32 v51, v51
    s_nop 0
    v_pk_add_f32 v[48:49], v[48:49], s[42:43]
    v_pk_add_f32 v[50:51], v[50:51], s[42:43]
    v_rcp_f32 v48, v48
    v_rcp_f32 v49, v49
    v_rcp_f32 v50, v50
    v_rcp_f32 v51, v51
    s_nop 0
    v_pk_mul_f32 v[168:169], v[168:169], v[48:49]
    v_pk_mul_f32 v[170:171], v[170:171], v[50:51]
    v_cvt_pk_bf16_f32 v48, v168, v169
    v_lshlrev_b32 v168, 16, v48
    v_and_b32 v169, 0xffff0000, v48
    v_cvt_pk_bf16_f32 v49, v170, v171
    v_lshlrev_b32 v170, 16, v49
    v_and_b32 v171, 0xffff0000, v49
    v_pk_mul_f32 v[168:169], v[168:169], v[232:233]
    v_pk_mul_f32 v[170:171], v[170:171], v[234:235]
    v_cvt_pk_bf16_f32 v64, v168, v169
    v_cvt_pk_bf16_f32 v65, v170, v171
    v_cvt_pk_bf16_f32 v52, v172, v173
    v_lshlrev_b32 v172, 16, v52
    v_and_b32 v173, 0xffff0000, v52
    v_cvt_pk_bf16_f32 v53, v174, v175
    v_lshlrev_b32 v174, 16, v53
    v_and_b32 v175, 0xffff0000, v53
    v_cvt_pk_bf16_f32 v54, v236, v237
    v_lshlrev_b32 v236, 16, v54
    v_and_b32 v237, 0xffff0000, v54
    v_cvt_pk_bf16_f32 v55, v238, v239
    v_lshlrev_b32 v238, 16, v55
    v_and_b32 v239, 0xffff0000, v55
    v_pk_mul_f32 v[52:53], v[172:173], s[40:41]
    v_pk_mul_f32 v[54:55], v[174:175], s[40:41]
    v_exp_f32 v52, v52
    v_exp_f32 v53, v53
    v_exp_f32 v54, v54
    v_exp_f32 v55, v55
    s_nop 0
    v_pk_add_f32 v[52:53], v[52:53], s[42:43]
    v_pk_add_f32 v[54:55], v[54:55], s[42:43]
    v_rcp_f32 v52, v52
    v_rcp_f32 v53, v53
    v_rcp_f32 v54, v54
    v_rcp_f32 v55, v55
    s_nop 0
    v_pk_mul_f32 v[172:173], v[172:173], v[52:53]
    v_pk_mul_f32 v[174:175], v[174:175], v[54:55]
    v_cvt_pk_bf16_f32 v52, v172, v173
    v_lshlrev_b32 v172, 16, v52
    v_and_b32 v173, 0xffff0000, v52
    v_cvt_pk_bf16_f32 v53, v174, v175
    v_lshlrev_b32 v174, 16, v53
    v_and_b32 v175, 0xffff0000, v53
    v_pk_mul_f32 v[172:173], v[172:173], v[236:237]
    v_pk_mul_f32 v[174:175], v[174:175], v[238:239]
    v_cvt_pk_bf16_f32 v66, v172, v173
    v_cvt_pk_bf16_f32 v67, v174, v175
    s_add_u32 s23, s22, 17408
    s_nop 0
    v_permlane16_swap_b32 v64, v66
    v_permlane16_swap_b32 v65, v67
    buffer_store_dwordx4 v[64:67], v27, s[12:15], s23 offen
    s_waitcnt lgkmcnt(0)
    s_cmp_eq_u32 s20, 0
    s_cbranch_scc0 Lg1_y1
    v_cvt_pk_bf16_f32 v40, v176, v177
    v_lshlrev_b32 v176, 16, v40
    v_and_b32 v177, 0xffff0000, v40
    v_cvt_pk_bf16_f32 v41, v178, v179
    v_lshlrev_b32 v178, 16, v41
    v_and_b32 v179, 0xffff0000, v41
    v_cvt_pk_bf16_f32 v42, v32, v33
    v_lshlrev_b32 v32, 16, v42
    v_and_b32 v33, 0xffff0000, v42
    v_cvt_pk_bf16_f32 v43, v34, v35
    v_lshlrev_b32 v34, 16, v43
    v_and_b32 v35, 0xffff0000, v43
    v_pk_mul_f32 v[40:41], v[176:177], s[40:41]
    v_pk_mul_f32 v[42:43], v[178:179], s[40:41]
    v_exp_f32 v40, v40
    v_exp_f32 v41, v41
    v_exp_f32 v42, v42
    v_exp_f32 v43, v43
    s_nop 0
    v_pk_add_f32 v[40:41], v[40:41], s[42:43]
    v_pk_add_f32 v[42:43], v[42:43], s[42:43]
    v_rcp_f32 v40, v40
    v_rcp_f32 v41, v41
    v_rcp_f32 v42, v42
    v_rcp_f32 v43, v43
    s_nop 0
    v_pk_mul_f32 v[176:177], v[176:177], v[40:41]
    v_pk_mul_f32 v[178:179], v[178:179], v[42:43]
    v_cvt_pk_bf16_f32 v40, v176, v177
    v_lshlrev_b32 v176, 16, v40
    v_and_b32 v177, 0xffff0000, v40
    v_cvt_pk_bf16_f32 v41, v178, v179
    v_lshlrev_b32 v178, 16, v41
    v_and_b32 v179, 0xffff0000, v41
    v_pk_mul_f32 v[176:177], v[176:177], v[32:33]
    v_pk_mul_f32 v[178:179], v[178:179], v[34:35]
    v_cvt_pk_bf16_f32 v68, v176, v177
    v_cvt_pk_bf16_f32 v69, v178, v179
    v_cvt_pk_bf16_f32 v44, v180, v181
    v_lshlrev_b32 v180, 16, v44
    v_and_b32 v181, 0xffff0000, v44
    v_cvt_pk_bf16_f32 v45, v182, v183
    v_lshlrev_b32 v182, 16, v45
    v_and_b32 v183, 0xffff0000, v45
    v_cvt_pk_bf16_f32 v46, v36, v37
    v_lshlrev_b32 v36, 16, v46
    v_and_b32 v37, 0xffff0000, v46
    v_cvt_pk_bf16_f32 v47, v38, v39
    v_lshlrev_b32 v38, 16, v47
    v_and_b32 v39, 0xffff0000, v47
    v_pk_mul_f32 v[44:45], v[180:181], s[40:41]
    v_pk_mul_f32 v[46:47], v[182:183], s[40:41]
    v_exp_f32 v44, v44
    v_exp_f32 v45, v45
    v_exp_f32 v46, v46
    v_exp_f32 v47, v47
    s_nop 0
    v_pk_add_f32 v[44:45], v[44:45], s[42:43]
    v_pk_add_f32 v[46:47], v[46:47], s[42:43]
    v_rcp_f32 v44, v44
    v_rcp_f32 v45, v45
    v_rcp_f32 v46, v46
    v_rcp_f32 v47, v47
    s_nop 0
    v_pk_mul_f32 v[180:181], v[180:181], v[44:45]
    v_pk_mul_f32 v[182:183], v[182:183], v[46:47]
    v_cvt_pk_bf16_f32 v44, v180, v181
    v_lshlrev_b32 v180, 16, v44
    v_and_b32 v181, 0xffff0000, v44
    v_cvt_pk_bf16_f32 v45, v182, v183
    v_lshlrev_b32 v182, 16, v45
    v_and_b32 v183, 0xffff0000, v45
    v_pk_mul_f32 v[180:181], v[180:181], v[36:37]
    v_pk_mul_f32 v[182:183], v[182:183], v[38:39]
    v_cvt_pk_bf16_f32 v70, v180, v181
    v_cvt_pk_bf16_f32 v71, v182, v183
    s_add_u32 s23, s21, 24576
    s_nop 0
    v_permlane16_swap_b32 v68, v70
    v_permlane16_swap_b32 v69, v71
    buffer_store_dwordx4 v[68:71], v27, s[12:15], s23 offen
    s_branch Lg1_fin
Lg1_y1:
    v_cvt_pk_bf16_f32 v48, v32, v33
    v_lshlrev_b32 v32, 16, v48
    v_and_b32 v33, 0xffff0000, v48
    v_cvt_pk_bf16_f32 v49, v34, v35
    v_lshlrev_b32 v34, 16, v49
    v_and_b32 v35, 0xffff0000, v49
    v_cvt_pk_bf16_f32 v50, v184, v185
    v_lshlrev_b32 v184, 16, v50
    v_and_b32 v185, 0xffff0000, v50
    v_cvt_pk_bf16_f32 v51, v186, v187
    v_lshlrev_b32 v186, 16, v51
    v_and_b32 v187, 0xffff0000, v51
    v_pk_mul_f32 v[48:49], v[32:33], s[40:41]
    v_pk_mul_f32 v[50:51], v[34:35], s[40:41]
    v_exp_f32 v48, v48
    v_exp_f32 v49, v49
    v_exp_f32 v50, v50
    v_exp_f32 v51, v51
    s_nop 0
    v_pk_add_f32 v[48:49], v[48:49], s[42:43]
    v_pk_add_f32 v[50:51], v[50:51], s[42:43]
    v_rcp_f32 v48, v48
    v_rcp_f32 v49, v49
    v_rcp_f32 v50, v50
    v_rcp_f32 v51, v51
    s_nop 0
    v_pk_mul_f32 v[32:33], v[32:33], v[48:49]
    v_pk_mul_f32 v[34:35], v[34:35], v[50:51]
    v_cvt_pk_bf16_f32 v48, v32, v33
    v_lshlrev_b32 v32, 16, v48
    v_and_b32 v33, 0xffff0000, v48
    v_cvt_pk_bf16_f32 v49, v34, v35
    v_lshlrev_b32 v34, 16, v49
    v_and_b32 v35, 0xffff0000, v49
    v_pk_mul_f32 v[32:33], v[32:33], v[184:185]
    v_pk_mul_f32 v[34:35], v[34:35], v[186:187]
    v_cvt_pk_bf16_f32 v72, v32, v33
    v_cvt_pk_bf16_f32 v73, v34, v35
    v_cvt_pk_bf16_f32 v52, v36, v37
    v_lshlrev_b32 v36, 16, v52
    v_and_b32 v37, 0xffff0000, v52
    v_cvt_pk_bf16_f32 v53, v38, v39
    v_lshlrev_b32 v38, 16, v53
    v_and_b32 v39, 0xffff0000, v53
    v_cvt_pk_bf16_f32 v54, v188, v189
    v_lshlrev_b32 v188, 16, v54
    v_and_b32 v189, 0xffff0000, v54
    v_cvt_pk_bf16_f32 v55, v190, v191
    v_lshlrev_b32 v190, 16, v55
    v_and_b32 v191, 0xffff0000, v55
    v_pk_mul_f32 v[52:53], v[36:37], s[40:41]
    v_pk_mul_f32 v[54:55], v[38:39], s[40:41]
    v_exp_f32 v52, v52
    v_exp_f32 v53, v53
    v_exp_f32 v54, v54
    v_exp_f32 v55, v55
    s_nop 0
    v_pk_add_f32 v[52:53], v[52:53], s[42:43]
    v_pk_add_f32 v[54:55], v[54:55], s[42:43]
    v_rcp_f32 v52, v52
    v_rcp_f32 v53, v53
    v_rcp_f32 v54, v54
    v_rcp_f32 v55, v55
    s_nop 0
    v_pk_mul_f32 v[36:37], v[36:37], v[52:53]
    v_pk_mul_f32 v[38:39], v[38:39], v[54:55]
    v_cvt_pk_bf16_f32 v52, v36, v37
    v_lshlrev_b32 v36, 16, v52
    v_and_b32 v37, 0xffff0000, v52
    v_cvt_pk_bf16_f32 v53, v38, v39
    v_lshlrev_b32 v38, 16, v53
    v_and_b32 v39, 0xffff0000, v53
    v_pk_mul_f32 v[36:37], v[36:37], v[188:189]
    v_pk_mul_f32 v[38:39], v[38:39], v[190:191]
    v_cvt_pk_bf16_f32 v74, v36, v37
    v_cvt_pk_bf16_f32 v75, v38, v39
    s_add_u32 s23, s21, 25600
    s_nop 0
    v_permlane16_swap_b32 v72, v74
    v_permlane16_swap_b32 v73, v75
    buffer_store_dwordx4 v[72:75], v27, s[12:15], s23 offen
Lg1_fin:
Lg1_end:
    s_endpgm
.text
.globl gemm2_kernel
.p2align 8
.type gemm2_kernel,@function
gemm2_kernel:
    s_cmp_ge_u32 s2, 256
    s_cbranch_scc1 Lg2_end
    s_load_dwordx2 s[24:25], s[0:1], 72
    s_load_dwordx2 s[26:27], s[0:1], 96
    s_load_dwordx2 s[28:29], s[0:1], 112
    v_lshrrev_b32 v1, 6, v0
    v_and_b32 v2, 63, v0
    v_readfirstlane_b32 s18, v1
    s_and_b32 s21, s2, 7
    s_lshr_b32 s22, s2, 3
    s_and_b32 s44, s22, 1
    s_lshr_b32 s22, s22, 1
    s_lshr_b32 s16, s21, 1
    s_lshl_b32 s16, s16, 2
    s_lshr_b32 s23, s22, 2
    s_add_u32 s16, s16, s23
    s_and_b32 s17, s21, 1
    s_lshl_b32 s17, s17, 2
    s_and_b32 s23, s22, 3
    s_add_u32 s17, s17, s23
    s_lshl_b32 s45, s16, 3
    s_add_u32 s45, s45, s17
    s_and_b32 s19, s18, 1
    s_lshr_b32 s20, s18, 1
    s_cmp_eq_u32 s44, 0
    s_cselect_b32 s46, 25, 31
    s_cselect_b32 s47, 0, 25
    v_lshrrev_b32 v20, 4, v2
    v_and_b32 v21, 15, v2
    v_lshrrev_b32 v22, 3, v2
    v_and_b32 v23, 7, v2
    v_xor_b32 v24, v23, v20
    v_lshrrev_b32 v25, 1, v24
    v_and_b32 v24, 1, v24
    v_lshlrev_b32 v25, 13, v25
    v_lshl_add_u32 v25, v22, 5, v25
    v_lshl_add_u32 v4, v24, 4, v25
    v_xor_b32 v24, v23, v20
    v_xor_b32 v24, 4, v24
    v_lshrrev_b32 v25, 1, v24
    v_and_b32 v24, 1, v24
    v_lshlrev_b32 v25, 13, v25
    v_lshl_add_u32 v25, v22, 5, v25
    v_lshl_add_u32 v5, v24, 4, v25
    s_lshl_b32 s21, s19, 2
    v_or_b32 v24, s21, v20
    v_lshrrev_b32 v25, 1, v21
    v_xor_b32 v24, v24, v25
    v_and_b32 v25, 1, v21
    v_lshlrev_b32 v24, 5, v24
    v_lshl_add_u32 v24, v25, 4, v24
    v_lshl_add_u32 v6, v20, 11, v24
    s_lshr_b32 s21, s16, 1
    s_mul_i32 s21, s21, 224
    s_lshl_b32 s22, s47, 2
    s_add_u32 s21, s21, s22
    s_lshl_b32 s30, s21, 13
    s_and_b32 s21, s16, 1
    s_lshl_b32 s21, s21, 12
    s_add_u32 s30, s30, s21
    s_lshl_b32 s21, s18, 9
    s_add_u32 s30, s30, s21
    s_lshl_b32 s21, s47, 17
    s_lshl_b32 s22, s18, 14
    s_add_u32 s31, s21, s22
    s_lshl_b32 s21, s17, 8
    s_add_u32 s31, s31, s21
    s_lshl_b32 s33, s18, 11
    s_mov_b32 s32, 0
    s_mov_b32 s48, 0
    s_waitcnt lgkmcnt(0)
    s_add_u32 s4, s28, 0x1000000
    s_addc_u32 s5, s29, 0
    s_mov_b32 s6, 0xe00000
    s_mov_b32 s7, 0x00020000
    s_mov_b32 s8, s24
    s_mov_b32 s9, s25
    s_mov_b32 s10, 0x700000
    s_mov_b32 s11, 0x00020000
    s_cmp_lt_u32 s48, s46
    s_cselect_b32 s36, s30, 0x80000000
    s_cselect_b32 s37, s31, 0x80000000
    s_add_u32 s49, s33, s32
    s_add_u32 m0, s49, 65536
    s_nop 0
    buffer_load_dwordx4 v4, s[4:7], s36 offen lds
    s_add_u32 m0, s49, 66560
    s_add_u32 s34, s36, 256
    buffer_load_dwordx4 v5, s[4:7], s34 offen lds
    s_add_u32 m0, s49, 0
    s_nop 0
    buffer_load_dwordx4 v6, s[8:11], s37 offen lds
    s_add_u32 m0, s49, 1024
    s_add_u32 s34, s37, 8192
    buffer_load_dwordx4 v6, s[8:11], s34 offen lds
    s_add_u32 s30, s30, 32768
    s_add_u32 s31, s31, 131072
    s_add_u32 s48, s48, 1
    s_add_u32 s32, s32, 16384
    s_and_b32 s32, s32, 0xffff
    s_barrier
    s_cmp_lt_u32 s48, s46
    s_cselect_b32 s36, s30, 0x80000000
    s_cselect_b32 s37, s31, 0x80000000
    s_add_u32 s49, s33, s32
    s_add_u32 m0, s49, 65536
    s_nop 0
    buffer_load_dwordx4 v4, s[4:7], s36 offen lds
    s_add_u32 m0, s49, 66560
    s_add_u32 s34, s36, 256
    buffer_load_dwordx4 v5, s[4:7], s34 offen lds
    s_add_u32 m0, s49, 0
    s_nop 0
    buffer_load_dwordx4 v6, s[8:11], s37 offen lds
    s_add_u32 m0, s49, 1024
    s_add_u32 s34, s37, 8192
    buffer_load_dwordx4 v6, s[8:11], s34 offen lds
    s_add_u32 s30, s30, 32768
    s_add_u32 s31, s31, 131072
    s_add_u32 s48, s48, 1
    s_add_u32 s32, s32, 16384
    s_and_b32 s32, s32, 0xffff
    v_lshrrev_b32 v24, 1, v21
    v_xor_b32 v24, v24, v20
    v_lshlrev_b32 v24, 4, v24
    v_lshl_add_u32 v24, v21, 7, v24
    s_lshl_b32 s21, s19, 13
    s_add_u32 s21, s21, 65536
    v_add_u32 v14, s21, v24
    v_xor_b32 v15, 64, v14
    v_lshrrev_b32 v24, 2, v21
    v_and_b32 v25, 3, v21
    v_and_b32 v26, 1, v20
    v_lshl_or_b32 v26, v26, 2, v24
    v_lshl_add_u32 v27, v20, 3, v24
    v_lshlrev_b32 v27, 8, v27
    v_lshl_add_u32 v27, v25, 3, v27
    s_lshl_b32 s21, s20, 1
    s_add_u32 s22, s21, 0
    v_xor_b32 v24, s22, v26
    v_lshl_add_u32 v16, v24, 5, v27
    s_add_u32 s22, s21, 1
    v_xor_b32 v24, s22, v26
    v_lshl_add_u32 v17, v24, 5, v27
    s_mov_b32 s38, 0
    s_mov_b32 s39, 0
    v_mov_b32 v96, 0
    v_mov_b32 v97, 0
    v_mov_b32 v98, 0
    v_mov_b32 v99, 0
    v_mov_b32 v100, 0
    v_mov_b32 v101, 0
    v_mov_b32 v102, 0
    v_mov_b32 v103, 0
    v_mov_b32 v104, 0
    v_mov_b32 v105, 0
    v_mov_b32 v106, 0
    v_mov_b32 v107, 0
    v_mov_b32 v108, 0
    v_mov_b32 v109, 0
    v_mov_b32 v110, 0
    v_mov_b32 v111, 0
    v_mov_b32 v112, 0
    v_mov_b32 v113, 0
    v_mov_b32 v114, 0
    v_mov_b32 v115, 0
    v_mov_b32 v116, 0
    v_mov_b32 v117, 0
    v_mov_b32 v118, 0
    v_mov_b32 v119, 0
    v_mov_b32 v120, 0
    v_mov_b32 v121, 0
    v_mov_b32 v122, 0
    v_mov_b32 v123, 0
    v_mov_b32 v124, 0
    v_mov_b32 v125, 0
    v_mov_b32 v126, 0
    v_mov_b32 v127, 0
    s_waitcnt vmcnt(4)
    s_barrier
    v_add_u32 v8, s38, v14
    v_add_u32 v10, s38, v16
    v_add_u32 v11, s38, v17
    s_add_u32 s38, s38, 16384
    s_and_b32 s38, s38, 0xffff
    ds_read_b128 v[32:35], v8 offset:0
    ds_read_b128 v[36:39], v8 offset:2048
    ds_read_b128 v[40:43], v8 offset:4096
    ds_read_b128 v[44:47], v8 offset:6144
    ds_read_b64_tr_b16 v[48:49], v10 offset:0
    ds_read_b64_tr_b16 v[50:51], v10 offset:1024
    ds_read_b64_tr_b16 v[52:53], v11 offset:0
    ds_read_b64_tr_b16 v[54:55], v11 offset:1024
    s_add_u32 s12, s28, 0x2000000
    s_addc_u32 s13, s29, 0
    s_mov_b32 s14, 0x800000
    s_mov_b32 s15, 0x00020000
    s_add_u32 s52, s28, 0x10000
    s_addc_u32 s53, s29, 0
    s_mov_b32 s54, 0x4000
    s_mov_b32 s55, 0x00020000
    v_lshlrev_b32 v24, 4, v2
    s_lshl_b32 s21, s45, 16
    s_lshl_b32 s22, s18, 13
    s_add_u32 s21, s21, s22
    s_lshl_b32 s22, s45, 7
    v_mov_b32 v25, 0
    s_sub_u32 s51, s46, 4
    s_waitcnt lgkmcnt(0)
    v_mfma_f32_16x16x32_bf16 v[96:99], v[48:51], v[32:35], v[96:99]
    v_add_u32 v9, s39, v15
    v_add_u32 v12, s39, v16
    v_add_u32 v13, s39, v17
    s_add_u32 s39, s39, 16384
    s_and_b32 s39, s39, 0xffff
    ds_read_b128 v[56:59], v9 offset:0
    ds_read_b128 v[60:63], v9 offset:2048
    s_cmp_lt_u32 s48, s46
    s_cselect_b32 s36, s30, 0x80000000
    s_cselect_b32 s37, s31, 0x80000000
    s_add_u32 s49, s33, s32
    s_add_u32 m0, s49, 65536
    s_nop 0
    buffer_load_dwordx4 v4, s[4:7], s36 offen lds
    v_mfma_f32_16x16x32_bf16 v[100:103], v[48:51], v[36:39], v[100:103]
    ds_read_b128 v[64:67], v9 offset:4096
    ds_read_b128 v[68:71], v9 offset:6144
    s_add_u32 m0, s49, 66560
    s_add_u32 s34, s36, 256
    buffer_load_dwordx4 v5, s[4:7], s34 offen lds
    v_mfma_f32_16x16x32_bf16 v[104:107], v[48:51], v[40:43], v[104:107]
    ds_read_b64_tr_b16 v[72:73], v12 offset:8192
    ds_read_b64_tr_b16 v[74:75], v12 offset:9216
    s_add_u32 m0, s49, 0
    s_nop 0
    buffer_load_dwordx4 v6, s[8:11], s37 offen lds
    v_mfma_f32_16x16x32_bf16 v[108:111], v[48:51], v[44:47], v[108:111]
    ds_read_b64_tr_b16 v[76:77], v13 offset:8192
    ds_read_b64_tr_b16 v[78:79], v13 offset:9216
    s_add_u32 m0, s49, 1024
    s_add_u32 s34, s37, 8192
    buffer_load_dwordx4 v6, s[8:11], s34 offen lds
    s_add_u32 s30, s30, 32768
    s_add_u32 s31, s31, 131072
    s_add_u32 s48, s48, 1
    s_add_u32 s32, s32, 16384
    s_and_b32 s32, s32, 0xffff
    v_mfma_f32_16x16x32_bf16 v[112:115], v[52:55], v[32:35], v[112:115]
    s_cmp_lt_u32 s48, s46
    s_cselect_b32 s36, s30, 0x80000000
    s_cselect_b32 s37, s31, 0x80000000
    s_add_u32 s49, s33, s32
    s_add_u32 m0, s49, 65536
    s_nop 0
    buffer_load_dwordx4 v4, s[4:7], s36 offen lds
    v_mfma_f32_16x16x32_bf16 v[116:119], v[52:55], v[36:39], v[116:119]
    s_add_u32 m0, s49, 66560
    s_add_u32 s34, s36, 256
    buffer_load_dwordx4 v5, s[4:7], s34 offen lds
    v_mfma_f32_16x16x32_bf16 v[120:123], v[52:55], v[40:43], v[120:123]
    s_add_u32 m0, s49, 0
    s_nop 0
    buffer_load_dwordx4 v6, s[8:11], s37 offen lds
    v_mfma_f32_16x16x32_bf16 v[124:127], v[52:55], v[44:47], v[124:127]
    s_add_u32 m0, s49, 1024
    s_add_u32 s34, s37, 8192
    buffer_load_dwordx4 v6, s[8:11], s34 offen lds
    s_add_u32 s30, s30, 32768
    s_add_u32 s31, s31, 131072
    s_add_u32 s48, s48, 1
    s_add_u32 s32, s32, 16384
    s_and_b32 s32, s32, 0xffff
    s_waitcnt vmcnt(8) lgkmcnt(0)
    s_barrier
    v_mfma_f32_16x16x32_bf16 v[96:99], v[72:75], v[56:59], v[96:99]
    v_add_u32 v8, s38, v14
    v_add_u32 v10, s38, v16
    v_add_u32 v11, s38, v17
    s_add_u32 s38, s38, 16384
    s_and_b32 s38, s38, 0xffff
    ds_read_b128 v[32:35], v8 offset:0
    ds_read_b128 v[36:39], v8 offset:2048
    v_mfma_f32_16x16x32_bf16 v[100:103], v[72:75], v[60:63], v[100:103]
    ds_read_b128 v[40:43], v8 offset:4096
    ds_read_b128 v[44:47], v8 offset:6144
    v_mfma_f32_16x16x32_bf16 v[104:107], v[72:75], v[64:67], v[104:107]
    ds_read_b64_tr_b16 v[48:49], v10 offset:0
    ds_read_b64_tr_b16 v[50:51], v10 offset:1024
    v_mfma_f32_16x16x32_bf16 v[108:111], v[72:75], v[68:71], v[108:111]
    ds_read_b64_tr_b16 v[52:53], v11 offset:0
    ds_read_b64_tr_b16 v[54:55], v11 offset:1024
    v_mfma_f32_16x16x32_bf16 v[112:115], v[76:79], v[56:59], v[112:115]
    s_cmp_lt_u32 s48, s46
    s_cselect_b32 s36, s30, 0x80000000
    s_cselect_b32 s37, s31, 0x80000000
    s_add_u32 s49, s33, s32
    s_add_u32 m0, s49, 65536
    s_nop 0
    buffer_load_dwordx4 v4, s[4:7], s36 offen lds
    v_mfma_f32_16x16x32_bf16 v[116:119], v[76:79], v[60:63], v[116:119]
    s_add_u32 m0, s49, 66560
    s_add_u32 s34, s36, 256
    buffer_load_dwordx4 v5, s[4:7], s34 offen lds
    v_mfma_f32_16x16x32_bf16 v[120:123], v[76:79], v[64:67], v[120:123]
    s_add_u32 m0, s49, 0
    s_nop 0
    buffer_load_dwordx4 v6, s[8:11], s37 offen lds
    v_mfma_f32_16x16x32_bf16 v[124:127], v[76:79], v[68:71], v[124:127]
    s_add_u32 m0, s49, 1024
    s_add_u32 s34, s37, 8192
    buffer_load_dwordx4 v6, s[8:11], s34 offen lds
    s_add_u32 s30, s30, 32768
    s_add_u32 s31, s31, 131072
    s_add_u32 s48, s48, 1
    s_add_u32 s32, s32, 16384
    s_and_b32 s32, s32, 0xffff
    s_mov_b32 s35, 1
Lg2_loop:
    s_waitcnt lgkmcnt(0)
    v_mfma_f32_16x16x32_bf16 v[96:99], v[48:51], v[32:35], v[96:99]
    v_add_u32 v9, s39, v15
    v_add_u32 v12, s39, v16
    v_add_u32 v13, s39, v17
    s_add_u32 s39, s39, 16384
    s_and_b32 s39, s39, 0xffff
    ds_read_b128 v[56:59], v9 offset:0
    ds_read_b128 v[60:63], v9 offset:2048
    v_mfma_f32_16x16x32_bf16 v[100:103], v[48:51], v[36:39], v[100:103]
    ds_read_b128 v[64:67], v9 offset:4096
    ds_read_b128 v[68:71], v9 offset:6144
    v_mfma_f32_16x16x32_bf16 v[104:107], v[48:51], v[40:43], v[104:107]
    ds_read_b64_tr_b16 v[72:73], v12 offset:8192
    ds_read_b64_tr_b16 v[74:75], v12 offset:9216
    v_mfma_f32_16x16x32_bf16 v[108:111], v[48:51], v[44:47], v[108:111]
    ds_read_b64_tr_b16 v[76:77], v13 offset:8192
    ds_read_b64_tr_b16 v[78:79], v13 offset:9216
    v_mfma_f32_16x16x32_bf16 v[112:115], v[52:55], v[32:35], v[112:115]
    v_mfma_f32_16x16x32_bf16 v[116:119], v[52:55], v[36:39], v[116:119]
    v_mfma_f32_16x16x32_bf16 v[120:123], v[52:55], v[40:43], v[120:123]
    v_mfma_f32_16x16x32_bf16 v[124:127], v[52:55], v[44:47], v[124:127]
    s_waitcnt vmcnt(8) lgkmcnt(0)
    s_barrier
    v_mfma_f32_16x16x32_bf16 v[96:99], v[72:75], v[56:59], v[96:99]
    v_add_u32 v8, s38, v14
    v_add_u32 v10, s38, v16
    v_add_u32 v11, s38, v17
    s_add_u32 s38, s38, 16384
    s_and_b32 s38, s38, 0xffff
    ds_read_b128 v[32:35], v8 offset:0
    ds_read_b128 v[36:39], v8 offset:2048
    v_mfma_f32_16x16x32_bf16 v[100:103], v[72:75], v[60:63], v[100:103]
    ds_read_b128 v[40:43], v8 offset:4096
    ds_read_b128 v[44:47], v8 offset:6144
    v_mfma_f32_16x16x32_bf16 v[104:107], v[72:75], v[64:67], v[104:107]
    ds_read_b64_tr_b16 v[48:49], v10 offset:0
    ds_read_b64_tr_b16 v[50:51], v10 offset:1024
    v_mfma_f32_16x16x32_bf16 v[108:111], v[72:75], v[68:71], v[108:111]
    ds_read_b64_tr_b16 v[52:53], v11 offset:0
    ds_read_b64_tr_b16 v[54:55], v11 offset:1024
    v_mfma_f32_16x16x32_bf16 v[112:115], v[76:79], v[56:59], v[112:115]
    s_cmp_lt_u32 s48, s46
    s_cselect_b32 s36, s30, 0x80000000
    s_cselect_b32 s37, s31, 0x80000000
    s_add_u32 s49, s33, s32
    s_add_u32 m0, s49, 65536
    s_nop 0
    buffer_load_dwordx4 v4, s[4:7], s36 offen lds
    v_mfma_f32_16x16x32_bf16 v[116:119], v[76:79], v[60:63], v[116:119]
    s_add_u32 m0, s49, 66560
    s_add_u32 s34, s36, 256
    buffer_load_dwordx4 v5, s[4:7], s34 offen lds
    v_mfma_f32_16x16x32_bf16 v[120:123], v[76:79], v[64:67], v[120:123]
    s_add_u32 m0, s49, 0
    s_nop 0
    buffer_load_dwordx4 v6, s[8:11], s37 offen lds
    v_mfma_f32_16x16x32_bf16 v[124:127], v[76:79], v[68:71], v[124:127]
    s_add_u32 m0, s49, 1024
    s_add_u32 s34, s37, 8192
    buffer_load_dwordx4 v6, s[8:11], s34 offen lds
    s_add_u32 s30, s30, 32768
    s_add_u32 s31, s31, 131072
    s_add_u32 s48, s48, 1
    s_add_u32 s32, s32, 16384
    s_and_b32 s32, s32, 0xffff
    s_add_u32 s35, s35, 1
    s_cmp_lt_u32 s35, s51
    s_cbranch_scc1 Lg2_loop
    s_waitcnt lgkmcnt(0)
    v_mfma_f32_16x16x32_bf16 v[96:99], v[48:51], v[32:35], v[96:99]
    v_add_u32 v9, s39, v15
    v_add_u32 v12, s39, v16
    v_add_u32 v13, s39, v17
    s_add_u32 s39, s39, 16384
    s_and_b32 s39, s39, 0xffff
    ds_read_b128 v[56:59], v9 offset:0
    ds_read_b128 v[60:63], v9 offset:2048
    v_mfma_f32_16x16x32_bf16 v[100:103], v[48:51], v[36:39], v[100:103]
    ds_read_b128 v[64:67], v9 offset:4096
    ds_read_b128 v[68:71], v9 offset:6144
    v_mfma_f32_16x16x32_bf16 v[104:107], v[48:51], v[40:43], v[104:107]
    ds_read_b64_tr_b16 v[72:73], v12 offset:8192
    ds_read_b64_tr_b16 v[74:75], v12 offset:9216
    v_mfma_f32_16x16x32_bf16 v[108:111], v[48:51], v[44:47], v[108:111]
    ds_read_b64_tr_b16 v[76:77], v13 offset:8192
    ds_read_b64_tr_b16 v[78:79], v13 offset:9216
    v_mfma_f32_16x16x32_bf16 v[112:115], v[52:55], v[32:35], v[112:115]
    v_mfma_f32_16x16x32_bf16 v[116:119], v[52:55], v[36:39], v[116:119]
    v_mfma_f32_16x16x32_bf16 v[120:123], v[52:55], v[40:43], v[120:123]
    v_mfma_f32_16x16x32_bf16 v[124:127], v[52:55], v[44:47], v[124:127]
    s_waitcnt vmcnt(8) lgkmcnt(0)
    s_barrier
    s_add_u32 s56, s28, 0x800000
    s_addc_u32 s57, s29, 0
    s_mov_b32 s58, 0x400000
    s_mov_b32 s59, 0x00020000
    s_add_u32 s60, s28, 0x5000
    s_addc_u32 s61, s29, 0
    s_mov_b32 s62, 0x7000
    s_mov_b32 s63, 0x00020000
    s_lshl_b32 s23, s17, 9
    s_lshl_b32 s34, s20, 7
    s_add_u32 s23, s23, s34
    v_lshlrev_b32 v26, 4, v20
    buffer_load_dwordx4 v[128:131], v26, s[60:63], s23 offen
    buffer_load_dwordx4 v[132:135], v26, s[60:63], s23 offen offset:64
    s_add_u32 s23, s23, 24576
    buffer_load_dwordx4 v[136:139], v26, s[60:63], s23 offen
    buffer_load_dwordx4 v[140:143], v26, s[60:63], s23 offen offset:64
    v_and_b32 v26, 1, v20
    v_lshl_add_u32 v26, v26, 4, v21
    v_lshlrev_b32 v26, 11, v26
    v_lshrrev_b32 v31, 1, v20
    v_lshl_add_u32 v31, v31, 4, v26
    s_lshl_b32 s23, s16, 18
    s_lshl_b32 s34, s19, 17
    s_add_u32 s23, s23, s34
    s_lshl_b32 s34, s17, 8
    s_add_u32 s23, s23, s34
    s_lshl_b32 s34, s20, 6
    s_add_u32 s50, s23, s34
    s_add_u32 s23, s50, 0
    buffer_load_dwordx4 v[144:147], v31, s[56:59], s23 offen offset:0
    s_add_u32 s23, s50, 65536
    buffer_load_dwordx4 v[148:151], v31, s[56:59], s23 offen offset:0
    s_add_u32 s23, s50, 0
    buffer_load_dwordx4 v[152:155], v31, s[56:59], s23 offen offset:32
    s_add_u32 s23, s50, 65536
    buffer_load_dwordx4 v[156:159], v31, s[56:59], s23 offen offset:32
    v_mfma_f32_16x16x32_bf16 v[96:99], v[72:75], v[56:59], v[96:99]
    v_add_u32 v8, s38, v14
    v_add_u32 v10, s38, v16
    v_add_u32 v11, s38, v17
    s_add_u32 s38, s38, 16384
    s_and_b32 s38, s38, 0xffff
    ds_read_b128 v[32:35], v8 offset:0
    ds_read_b128 v[36:39], v8 offset:2048
    v_mfma_f32_16x16x32_bf16 v[100:103], v[72:75], v[60:63], v[100:103]
    ds_read_b128 v[40:43], v8 offset:4096
    ds_read_b128 v[44:47], v8 offset:6144
    v_mfma_f32_16x16x32_bf16 v[104:107], v[72:75], v[64:67], v[104:107]
    ds_read_b64_tr_b16 v[48:49], v10 offset:0
    ds_read_b64_tr_b16 v[50:51], v10 offset:1024
    v_mfma_f32_16x16x32_bf16 v[108:111], v[72:75], v[68:71], v[108:111]
    ds_read_b64_tr_b16 v[52:53], v11 offset:0
    ds_read_b64_tr_b16 v[54:55], v11 offset:1024
    v_mfma_f32_16x16x32_bf16 v[112:115], v[76:79], v[56:59], v[112:115]
    v_mfma_f32_16x16x32_bf16 v[116:119], v[76:79], v[60:63], v[116:119]
    v_mfma_f32_16x16x32_bf16 v[120:123], v[76:79], v[64:67], v[120:123]
    v_mfma_f32_16x16x32_bf16 v[124:127], v[76:79], v[68:71], v[124:127]
    s_waitcnt lgkmcnt(0)
    v_mfma_f32_16x16x32_bf16 v[96:99], v[48:51], v[32:35], v[96:99]
    v_add_u32 v9, s39, v15
    v_add_u32 v12, s39, v16
    v_add_u32 v13, s39, v17
    s_add_u32 s39, s39, 16384
    s_and_b32 s39, s39, 0xffff
    ds_read_b128 v[56:59], v9 offset:0
    ds_read_b128 v[60:63], v9 offset:2048
    v_mfma_f32_16x16x32_bf16 v[100:103], v[48:51], v[36:39], v[100:103]
    ds_read_b128 v[64:67], v9 offset:4096
    ds_read_b128 v[68:71], v9 offset:6144
    v_mfma_f32_16x16x32_bf16 v[104:107], v[48:51], v[40:43], v[104:107]
    ds_read_b64_tr_b16 v[72:73], v12 offset:8192
    ds_read_b64_tr_b16 v[74:75], v12 offset:9216
    v_mfma_f32_16x16x32_bf16 v[108:111], v[48:51], v[44:47], v[108:111]
    ds_read_b64_tr_b16 v[76:77], v13 offset:8192
    ds_read_b64_tr_b16 v[78:79], v13 offset:9216
    v_mfma_f32_16x16x32_bf16 v[112:115], v[52:55], v[32:35], v[112:115]
    v_mfma_f32_16x16x32_bf16 v[116:119], v[52:55], v[36:39], v[116:119]
    v_mfma_f32_16x16x32_bf16 v[120:123], v[52:55], v[40:43], v[120:123]
    v_mfma_f32_16x16x32_bf16 v[124:127], v[52:55], v[44:47], v[124:127]
    s_waitcnt vmcnt(12) lgkmcnt(0)
    s_barrier
    buffer_load_dword v28, v25, s[52:55], s22 offen sc0 sc1
    v_mfma_f32_16x16x32_bf16 v[96:99], v[72:75], v[56:59], v[96:99]
    v_add_u32 v8, s38, v14
    v_add_u32 v10, s38, v16
    v_add_u32 v11, s38, v17
    s_add_u32 s38, s38, 16384
    s_and_b32 s38, s38, 0xffff
    ds_read_b128 v[32:35], v8 offset:0
    ds_read_b128 v[36:39], v8 offset:2048
    v_mfma_f32_16x16x32_bf16 v[100:103], v[72:75], v[60:63], v[100:103]
    ds_read_b128 v[40:43], v8 offset:4096
    ds_read_b128 v[44:47], v8 offset:6144
    v_mfma_f32_16x16x32_bf16 v[104:107], v[72:75], v[64:67], v[104:107]
    ds_read_b64_tr_b16 v[48:49], v10 offset:0
    ds_read_b64_tr_b16 v[50:51], v10 offset:1024
    v_mfma_f32_16x16x32_bf16 v[108:111], v[72:75], v[68:71], v[108:111]
    ds_read_b64_tr_b16 v[52:53], v11 offset:0
    ds_read_b64_tr_b16 v[54:55], v11 offset:1024
    v_mfma_f32_16x16x32_bf16 v[112:115], v[76:79], v[56:59], v[112:115]
    v_mfma_f32_16x16x32_bf16 v[116:119], v[76:79], v[60:63], v[116:119]
    v_mfma_f32_16x16x32_bf16 v[120:123], v[76:79], v[64:67], v[120:123]
    v_mfma_f32_16x16x32_bf16 v[124:127], v[76:79], v[68:71], v[124:127]
    s_waitcnt lgkmcnt(0)
    v_mfma_f32_16x16x32_bf16 v[96:99], v[48:51], v[32:35], v[96:99]
    v_add_u32 v9, s39, v15
    v_add_u32 v12, s39, v16
    v_add_u32 v13, s39, v17
    s_add_u32 s39, s39, 16384
    s_and_b32 s39, s39, 0xffff
    ds_read_b128 v[56:59], v9 offset:0
    ds_read_b128 v[60:63], v9 offset:2048
    v_mfma_f32_16x16x32_bf16 v[100:103], v[48:51], v[36:39], v[100:103]
    ds_read_b128 v[64:67], v9 offset:4096
    ds_read_b128 v[68:71], v9 offset:6144
    v_mfma_f32_16x16x32_bf16 v[104:107], v[48:51], v[40:43], v[104:107]
    ds_read_b64_tr_b16 v[72:73], v12 offset:8192
    ds_read_b64_tr_b16 v[74:75], v12 offset:9216
    v_mfma_f32_16x16x32_bf16 v[108:111], v[48:51], v[44:47], v[108:111]
    ds_read_b64_tr_b16 v[76:77], v13 offset:8192
    ds_read_b64_tr_b16 v[78:79], v13 offset:9216
    v_mfma_f32_16x16x32_bf16 v[112:115], v[52:55], v[32:35], v[112:115]
    v_mfma_f32_16x16x32_bf16 v[116:119], v[52:55], v[36:39], v[116:119]
    v_mfma_f32_16x16x32_bf16 v[120:123], v[52:55], v[40:43], v[120:123]
    v_mfma_f32_16x16x32_bf16 v[124:127], v[52:55], v[44:47], v[124:127]
    s_waitcnt vmcnt(9) lgkmcnt(0)
    s_barrier
    s_cmp_eq_u32 s44, 0
    s_cbranch_scc1 Lg2_nopart
    s_waitcnt vmcnt(0)
Lg2_poll:
    v_readfirstlane_b32 s34, v28
    s_cmp_eq_u32 s34, 1
    s_cbranch_scc1 Lg2_got
    s_sleep 1
    buffer_load_dword v28, v25, s[52:55], s22 offen sc0 sc1
    s_waitcnt vmcnt(0)
    s_branch Lg2_poll
Lg2_got:
    s_add_u32 s23, s21, 0
    buffer_load_dwordx4 v[160:163], v24, s[12:15], s23 offen sc0 sc1
    s_add_u32 s23, s21, 1024
    buffer_load_dwordx4 v[164:167], v24, s[12:15], s23 offen sc0 sc1
    s_add_u32 s23, s21, 2048
    buffer_load_dwordx4 v[168:171], v24, s[12:15], s23 offen sc0 sc1
    s_add_u32 s23, s21, 3072
    buffer_load_dwordx4 v[172:175], v24, s[12:15], s23 offen sc0 sc1
    s_add_u32 s23, s21, 4096
    buffer_load_dwordx4 v[176:179], v24, s[12:15], s23 offen sc0 sc1
    s_add_u32 s23, s21, 5120
    buffer_load_dwordx4 v[180:183], v24, s[12:15], s23 offen sc0 sc1
    s_add_u32 s23, s21, 6144
    buffer_load_dwordx4 v[184:187], v24, s[12:15], s23 offen sc0 sc1
    s_add_u32 s23, s21, 7168
    buffer_load_dwordx4 v[188:191], v24, s[12:15], s23 offen sc0 sc1
Lg2_nopart:
    v_mfma_f32_16x16x32_bf16 v[96:99], v[72:75], v[56:59], v[96:99]
    v_add_u32 v8, s38, v14
    v_add_u32 v10, s38, v16
    v_add_u32 v11, s38, v17
    s_add_u32 s38, s38, 16384
    s_and_b32 s38, s38, 0xffff
    ds_read_b128 v[32:35], v8 offset:0
    ds_read_b128 v[36:39], v8 offset:2048
    v_mfma_f32_16x16x32_bf16 v[100:103], v[72:75], v[60:63], v[100:103]
    ds_read_b128 v[40:43], v8 offset:4096
    ds_read_b128 v[44:47], v8 offset:6144
    v_mfma_f32_16x16x32_bf16 v[104:107], v[72:75], v[64:67], v[104:107]
    ds_read_b64_tr_b16 v[48:49], v10 offset:0
    ds_read_b64_tr_b16 v[50:51], v10 offset:1024
    v_mfma_f32_16x16x32_bf16 v[108:111], v[72:75], v[68:71], v[108:111]
    ds_read_b64_tr_b16 v[52:53], v11 offset:0
    ds_read_b64_tr_b16 v[54:55], v11 offset:1024
    v_mfma_f32_16x16x32_bf16 v[112:115], v[76:79], v[56:59], v[112:115]
    v_mfma_f32_16x16x32_bf16 v[116:119], v[76:79], v[60:63], v[116:119]
    v_mfma_f32_16x16x32_bf16 v[120:123], v[76:79], v[64:67], v[120:123]
    v_mfma_f32_16x16x32_bf16 v[124:127], v[76:79], v[68:71], v[124:127]
    s_waitcnt lgkmcnt(0)
    v_mfma_f32_16x16x32_bf16 v[96:99], v[48:51], v[32:35], v[96:99]
    v_add_u32 v9, s39, v15
    v_add_u32 v12, s39, v16
    v_add_u32 v13, s39, v17
    s_add_u32 s39, s39, 16384
    s_and_b32 s39, s39, 0xffff
    ds_read_b128 v[56:59], v9 offset:0
    ds_read_b128 v[60:63], v9 offset:2048
    v_mfma_f32_16x16x32_bf16 v[100:103], v[48:51], v[36:39], v[100:103]
    ds_read_b128 v[64:67], v9 offset:4096
    ds_read_b128 v[68:71], v9 offset:6144
    v_mfma_f32_16x16x32_bf16 v[104:107], v[48:51], v[40:43], v[104:107]
    ds_read_b64_tr_b16 v[72:73], v12 offset:8192
    ds_read_b64_tr_b16 v[74:75], v12 offset:9216
    v_mfma_f32_16x16x32_bf16 v[108:111], v[48:51], v[44:47], v[108:111]
    ds_read_b64_tr_b16 v[76:77], v13 offset:8192
    ds_read_b64_tr_b16 v[78:79], v13 offset:9216
    v_mfma_f32_16x16x32_bf16 v[112:115], v[52:55], v[32:35], v[112:115]
    v_mfma_f32_16x16x32_bf16 v[116:119], v[52:55], v[36:39], v[116:119]
    v_mfma_f32_16x16x32_bf16 v[120:123], v[52:55], v[40:43], v[120:123]
    v_mfma_f32_16x16x32_bf16 v[124:127], v[52:55], v[44:47], v[124:127]
    s_waitcnt lgkmcnt(0)
    s_barrier
    v_mfma_f32_16x16x32_bf16 v[96:99], v[72:75], v[56:59], v[96:99]
    v_add_u32 v8, s38, v14
    v_add_u32 v10, s38, v16
    v_add_u32 v11, s38, v17
    s_add_u32 s38, s38, 16384
    s_and_b32 s38, s38, 0xffff
    ds_read_b128 v[32:35], v8 offset:0
    ds_read_b128 v[36:39], v8 offset:2048
    v_mfma_f32_16x16x32_bf16 v[100:103], v[72:75], v[60:63], v[100:103]
    ds_read_b128 v[40:43], v8 offset:4096
    ds_read_b128 v[44:47], v8 offset:6144
    v_mfma_f32_16x16x32_bf16 v[104:107], v[72:75], v[64:67], v[104:107]
    ds_read_b64_tr_b16 v[48:49], v10 offset:0
    ds_read_b64_tr_b16 v[50:51], v10 offset:1024
    v_mfma_f32_16x16x32_bf16 v[108:111], v[72:75], v[68:71], v[108:111]
    ds_read_b64_tr_b16 v[52:53], v11 offset:0
    ds_read_b64_tr_b16 v[54:55], v11 offset:1024
    v_mfma_f32_16x16x32_bf16 v[112:115], v[76:79], v[56:59], v[112:115]
    v_mfma_f32_16x16x32_bf16 v[116:119], v[76:79], v[60:63], v[116:119]
    v_mfma_f32_16x16x32_bf16 v[120:123], v[76:79], v[64:67], v[120:123]
    v_mfma_f32_16x16x32_bf16 v[124:127], v[76:79], v[68:71], v[124:127]
    s_waitcnt lgkmcnt(0)
    s_nop 7
    s_cmp_eq_u32 s44, 0
    s_cbranch_scc0 Lg2_late
    s_add_u32 s23, s21, 0
    buffer_store_dwordx4 v[96:99], v24, s[12:15], s23 offen sc0 sc1
    s_add_u32 s23, s21, 1024
    buffer_store_dwordx4 v[100:103], v24, s[12:15], s23 offen sc0 sc1
    s_add_u32 s23, s21, 2048
    buffer_store_dwordx4 v[104:107], v24, s[12:15], s23 offen sc0 sc1
    s_add_u32 s23, s21, 3072
    buffer_store_dwordx4 v[108:111], v24, s[12:15], s23 offen sc0 sc1
    s_add_u32 s23, s21, 4096
    buffer_store_dwordx4 v[112:115], v24, s[12:15], s23 offen sc0 sc1
    s_add_u32 s23, s21, 5120
    buffer_store_dwordx4 v[116:119], v24, s[12:15], s23 offen sc0 sc1
    s_add_u32 s23, s21, 6144
    buffer_store_dwordx4 v[120:123], v24, s[12:15], s23 offen sc0 sc1
    s_add_u32 s23, s21, 7168
    buffer_store_dwordx4 v[124:127], v24, s[12:15], s23 offen sc0 sc1
    s_waitcnt vmcnt(0)
    s_barrier
    s_cmp_eq_u32 s18, 0
    s_cbranch_scc0 Lg2_fin
    v_mov_b32 v26, 1
    v_cmp_eq_u32 vcc, 0, v2
    s_and_saveexec_b64 s[56:57], vcc
    buffer_store_dword v26, v25, s[52:55], s22 offen sc0 sc1
    s_waitcnt vmcnt(0)
    s_mov_b64 exec, s[56:57]
    s_branch Lg2_fin
Lg2_late:
    v_add_f32 v32, v128, v136
    v_add_f32 v33, v129, v137
    v_add_f32 v34, v130, v138
    v_add_f32 v35, v131, v139
    v_add_f32 v36, v132, v140
    v_add_f32 v37, v133, v141
    v_add_f32 v38, v134, v142
    v_add_f32 v39, v135, v143
    v_cvt_pk_bf16_f32 v28, v32, v33
    v_lshlrev_b32 v32, 16, v28
    v_and_b32 v33, 0xffff0000, v28
    v_cvt_pk_bf16_f32 v28, v34, v35
    v_lshlrev_b32 v34, 16, v28
    v_and_b32 v35, 0xffff0000, v28
    v_cvt_pk_bf16_f32 v28, v36, v37
    v_lshlrev_b32 v36, 16, v28
    v_and_b32 v37, 0xffff0000, v28
    v_cvt_pk_bf16_f32 v28, v38, v39
    v_lshlrev_b32 v38, 16, v28
    v_and_b32 v39, 0xffff0000, v28
    v_mov_b32 v27, v31
    s_mov_b32 s12, s26
    s_mov_b32 s13, s27
    s_mov_b32 s14, 0x400000
    s_mov_b32 s15, 0x00020000
    s_waitcnt vmcnt(7)
    v_add_f32 v96, v96, v160
    v_add_f32 v97, v97, v161
    v_add_f32 v98, v98, v162
    v_add_f32 v99, v99, v163
    v_cvt_pk_bf16_f32 v160, v96, v97
    v_cvt_pk_bf16_f32 v161, v98, v99
    v_lshlrev_b32 v96, 16, v160
    v_and_b32 v97, 0xffff0000, v160
    v_lshlrev_b32 v98, 16, v161
    v_and_b32 v99, 0xffff0000, v161
    v_mul_f32 v96, v96, v32
    v_mul_f32 v97, v97, v33
    v_mul_f32 v98, v98, v34
    v_mul_f32 v99, v99, v35
    v_cvt_pk_bf16_f32 v56, v96, v97
    v_cvt_pk_bf16_f32 v57, v98, v99
    s_waitcnt vmcnt(6)
    v_add_f32 v100, v100, v164
    v_add_f32 v101, v101, v165
    v_add_f32 v102, v102, v166
    v_add_f32 v103, v103, v167
    v_cvt_pk_bf16_f32 v164, v100, v101
    v_cvt_pk_bf16_f32 v165, v102, v103
    v_lshlrev_b32 v100, 16, v164
    v_and_b32 v101, 0xffff0000, v164
    v_lshlrev_b32 v102, 16, v165
    v_and_b32 v103, 0xffff0000, v165
    v_mul_f32 v100, v100, v32
    v_mul_f32 v101, v101, v33
    v_mul_f32 v102, v102, v34
    v_mul_f32 v103, v103, v35
    v_cvt_pk_bf16_f32 v58, v100, v101
    v_cvt_pk_bf16_f32 v59, v102, v103
    s_nop 1
    v_permlane16_swap_b32 v56, v58
    v_permlane16_swap_b32 v57, v59
    v_lshlrev_b32 v96, 16, v56
    v_and_b32 v97, 0xffff0000, v56
    v_lshlrev_b32 v28, 16, v144
    v_and_b32 v29, 0xffff0000, v144
    v_add_f32 v96, v96, v28
    v_add_f32 v97, v97, v29
    v_cvt_pk_bf16_f32 v144, v96, v97
    v_lshlrev_b32 v98, 16, v57
    v_and_b32 v99, 0xffff0000, v57
    v_lshlrev_b32 v28, 16, v145
    v_and_b32 v29, 0xffff0000, v145
    v_add_f32 v98, v98, v28
    v_add_f32 v99, v99, v29
    v_cvt_pk_bf16_f32 v145, v98, v99
    v_lshlrev_b32 v100, 16, v58
    v_and_b32 v101, 0xffff0000, v58
    v_lshlrev_b32 v28, 16, v146
    v_and_b32 v29, 0xffff0000, v146
    v_add_f32 v100, v100, v28
    v_add_f32 v101, v101, v29
    v_cvt_pk_bf16_f32 v146, v100, v101
    v_lshlrev_b32 v102, 16, v59
    v_and_b32 v103, 0xffff0000, v59
    v_lshlrev_b32 v28, 16, v147
    v_and_b32 v29, 0xffff0000, v147
    v_add_f32 v102, v102, v28
    v_add_f32 v103, v103, v29
    v_cvt_pk_bf16_f32 v147, v102, v103
    s_add_u32 s23, s50, 0
    buffer_store_dwordx4 v[144:147], v27, s[12:15], s23 offen offset:0
    s_waitcnt vmcnt(6)
    v_add_f32 v104, v104, v168
    v_add_f32 v105, v105, v169
    v_add_f32 v106, v106, v170
    v_add_f32 v107, v107, v171
    v_cvt_pk_bf16_f32 v168, v104, v105
    v_cvt_pk_bf16_f32 v169, v106, v107
    v_lshlrev_b32 v104, 16, v168
    v_and_b32 v105, 0xffff0000, v168
    v_lshlrev_b32 v106, 16, v169
    v_and_b32 v107, 0xffff0000, v169
    v_mul_f32 v104, v104, v32
    v_mul_f32 v105, v105, v33
    v_mul_f32 v106, v106, v34
    v_mul_f32 v107, v107, v35
    v_cvt_pk_bf16_f32 v60, v104, v105
    v_cvt_pk_bf16_f32 v61, v106, v107
    s_waitcnt vmcnt(5)
    v_add_f32 v108, v108, v172
    v_add_f32 v109, v109, v173
    v_add_f32 v110, v110, v174
    v_add_f32 v111, v111, v175
    v_cvt_pk_bf16_f32 v172, v108, v109
    v_cvt_pk_bf16_f32 v173, v110, v111
    v_lshlrev_b32 v108, 16, v172
    v_and_b32 v109, 0xffff0000, v172
    v_lshlrev_b32 v110, 16, v173
    v_and_b32 v111, 0xffff0000, v173
    v_mul_f32 v108, v108, v32
    v_mul_f32 v109, v109, v33
    v_mul_f32 v110, v110, v34
    v_mul_f32 v111, v111, v35
    v_cvt_pk_bf16_f32 v62, v108, v109
    v_cvt_pk_bf16_f32 v63, v110, v111
    s_nop 1
    v_permlane16_swap_b32 v60, v62
    v_permlane16_swap_b32 v61, v63
    v_lshlrev_b32 v104, 16, v60
    v_and_b32 v105, 0xffff0000, v60
    v_lshlrev_b32 v28, 16, v148
    v_and_b32 v29, 0xffff0000, v148
    v_add_f32 v104, v104, v28
    v_add_f32 v105, v105, v29
    v_cvt_pk_bf16_f32 v148, v104, v105
    v_lshlrev_b32 v106, 16, v61
    v_and_b32 v107, 0xffff0000, v61
    v_lshlrev_b32 v28, 16, v149
    v_and_b32 v29, 0xffff0000, v149
    v_add_f32 v106, v106, v28
    v_add_f32 v107, v107, v29
    v_cvt_pk_bf16_f32 v149, v106, v107
    v_lshlrev_b32 v108, 16, v62
    v_and_b32 v109, 0xffff0000, v62
    v_lshlrev_b32 v28, 16, v150
    v_and_b32 v29, 0xffff0000, v150
    v_add_f32 v108, v108, v28
    v_add_f32 v109, v109, v29
    v_cvt_pk_bf16_f32 v150, v108, v109
    v_lshlrev_b32 v110, 16, v63
    v_and_b32 v111, 0xffff0000, v63
    v_lshlrev_b32 v28, 16, v151
    v_and_b32 v29, 0xffff0000, v151
    v_add_f32 v110, v110, v28
    v_add_f32 v111, v111, v29
    v_cvt_pk_bf16_f32 v151, v110, v111
    s_add_u32 s23, s50, 65536
    buffer_store_dwordx4 v[148:151], v27, s[12:15], s23 offen offset:0
    s_waitcnt vmcnt(5)
    v_add_f32 v112, v112, v176
    v_add_f32 v113, v113, v177
    v_add_f32 v114, v114, v178
    v_add_f32 v115, v115, v179
    v_cvt_pk_bf16_f32 v176, v112, v113
    v_cvt_pk_bf16_f32 v177, v114, v115
    v_lshlrev_b32 v112, 16, v176
    v_and_b32 v113, 0xffff0000, v176
    v_lshlrev_b32 v114, 16, v177
    v_and_b32 v115, 0xffff0000, v177
    v_mul_f32 v112, v112, v36
    v_mul_f32 v113, v113, v37
    v_mul_f32 v114, v114, v38
    v_mul_f32 v115, v115, v39
    v_cvt_pk_bf16_f32 v56, v112, v113
    v_cvt_pk_bf16_f32 v57, v114, v115
    s_waitcnt vmcnt(4)
    v_add_f32 v116, v116, v180
    v_add_f32 v117, v117, v181
    v_add_f32 v118, v118, v182
    v_add_f32 v119, v119, v183
    v_cvt_pk_bf16_f32 v180, v116, v117
    v_cvt_pk_bf16_f32 v181, v118, v119
    v_lshlrev_b32 v116, 16, v180
    v_and_b32 v117, 0xffff0000, v180
    v_lshlrev_b32 v118, 16, v181
    v_and_b32 v119, 0xffff0000, v181
    v_mul_f32 v116, v116, v36
    v_mul_f32 v117, v117, v37
    v_mul_f32 v118, v118, v38
    v_mul_f32 v119, v119, v39
    v_cvt_pk_bf16_f32 v58, v116, v117
    v_cvt_pk_bf16_f32 v59, v118, v119
    s_nop 1
    v_permlane16_swap_b32 v56, v58
    v_permlane16_swap_b32 v57, v59
    v_lshlrev_b32 v112, 16, v56
    v_and_b32 v113, 0xffff0000, v56
    v_lshlrev_b32 v28, 16, v152
    v_and_b32 v29, 0xffff0000, v152
    v_add_f32 v112, v112, v28
    v_add_f32 v113, v113, v29
    v_cvt_pk_bf16_f32 v152, v112, v113
    v_lshlrev_b32 v114, 16, v57
    v_and_b32 v115, 0xffff0000, v57
    v_lshlrev_b32 v28, 16, v153
    v_and_b32 v29, 0xffff0000, v153
    v_add_f32 v114, v114, v28
    v_add_f32 v115, v115, v29
    v_cvt_pk_bf16_f32 v153, v114, v115
    v_lshlrev_b32 v116, 16, v58
    v_and_b32 v117, 0xffff0000, v58
    v_lshlrev_b32 v28, 16, v154
    v_and_b32 v29, 0xffff0000, v154
    v_add_f32 v116, v116, v28
    v_add_f32 v117, v117, v29
    v_cvt_pk_bf16_f32 v154, v116, v117
    v_lshlrev_b32 v118, 16, v59
    v_and_b32 v119, 0xffff0000, v59
    v_lshlrev_b32 v28, 16, v155
    v_and_b32 v29, 0xffff0000, v155
    v_add_f32 v118, v118, v28
    v_add_f32 v119, v119, v29
    v_cvt_pk_bf16_f32 v155, v118, v119
    s_add_u32 s23, s50, 0
    buffer_store_dwordx4 v[152:155], v27, s[12:15], s23 offen offset:32
    s_waitcnt vmcnt(4)
    v_add_f32 v120, v120, v184
    v_add_f32 v121, v121, v185
    v_add_f32 v122, v122, v186
    v_add_f32 v123, v123, v187
    v_cvt_pk_bf16_f32 v184, v120, v121
    v_cvt_pk_bf16_f32 v185, v122, v123
    v_lshlrev_b32 v120, 16, v184
    v_and_b32 v121, 0xffff0000, v184
    v_lshlrev_b32 v122, 16, v185
    v_and_b32 v123, 0xffff0000, v185
    v_mul_f32 v120, v120, v36
    v_mul_f32 v121, v121, v37
    v_mul_f32 v122, v122, v38
    v_mul_f32 v123, v123, v39
    v_cvt_pk_bf16_f32 v60, v120, v121
    v_cvt_pk_bf16_f32 v61, v122, v123
    s_waitcnt vmcnt(3)
    v_add_f32 v124, v124, v188
    v_add_f32 v125, v125, v189
    v_add_f32 v126, v126, v190
    v_add_f32 v127, v127, v191
    v_cvt_pk_bf16_f32 v188, v124, v125
    v_cvt_pk_bf16_f32 v189, v126, v127
    v_lshlrev_b32 v124, 16, v188
    v_and_b32 v125, 0xffff0000, v188
    v_lshlrev_b32 v126, 16, v189
    v_and_b32 v127, 0xffff0000, v189
    v_mul_f32 v124, v124, v36
    v_mul_f32 v125, v125, v37
    v_mul_f32 v126, v126, v38
    v_mul_f32 v127, v127, v39
    v_cvt_pk_bf16_f32 v62, v124, v125
    v_cvt_pk_bf16_f32 v63, v126, v127
    s_nop 1
    v_permlane16_swap_b32 v60, v62
    v_permlane16_swap_b32 v61, v63
    v_lshlrev_b32 v120, 16, v60
    v_and_b32 v121, 0xffff0000, v60
    v_lshlrev_b32 v28, 16, v156
    v_and_b32 v29, 0xffff0000, v156
    v_add_f32 v120, v120, v28
    v_add_f32 v121, v121, v29
    v_cvt_pk_bf16_f32 v156, v120, v121
    v_lshlrev_b32 v122, 16, v61
    v_and_b32 v123, 0xffff0000, v61
    v_lshlrev_b32 v28, 16, v157
    v_and_b32 v29, 0xffff0000, v157
    v_add_f32 v122, v122, v28
    v_add_f32 v123, v123, v29
    v_cvt_pk_bf16_f32 v157, v122, v123
    v_lshlrev_b32 v124, 16, v62
    v_and_b32 v125, 0xffff0000, v62
    v_lshlrev_b32 v28, 16, v158
    v_and_b32 v29, 0xffff0000, v158
    v_add_f32 v124, v124, v28
    v_add_f32 v125, v125, v29
    v_cvt_pk_bf16_f32 v158, v124, v125
    v_lshlrev_b32 v126, 16, v63
    v_and_b32 v127, 0xffff0000, v63
    v_lshlrev_b32 v28, 16, v159
    v_and_b32 v29, 0xffff0000, v159
    v_add_f32 v126, v126, v28
    v_add_f32 v127, v127, v29
    v_cvt_pk_bf16_f32 v159, v126, v127
    s_add_u32 s23, s50, 65536
    buffer_store_dwordx4 v[156:159], v27, s[12:15], s23 offen offset:32
Lg2_fin:
Lg2_end:
    s_endpgm
.section .rodata,"a"
.p2align 6
.amdhsa_kernel kvt_kernel
.amdhsa_next_free_vgpr 168
.amdhsa_next_free_sgpr 102
.amdhsa_accum_offset 168
.amdhsa_group_segment_fixed_size 0
.amdhsa_kernarg_size 120
.amdhsa_user_sgpr_count 2
.amdhsa_user_sgpr_kernarg_segment_ptr 1
.amdhsa_system_sgpr_workgroup_id_x 1
.end_amdhsa_kernel
.section .rodata,"a"
.p2align 6
.amdhsa_kernel conv_kernel
.amdhsa_next_free_vgpr 192
.amdhsa_next_free_sgpr 102
.amdhsa_accum_offset 192
.amdhsa_group_segment_fixed_size 0
.amdhsa_kernarg_size 120
.amdhsa_user_sgpr_count 2
.amdhsa_user_sgpr_kernarg_segment_ptr 1
.amdhsa_system_sgpr_workgroup_id_x 1
.end_amdhsa_kernel
.section .rodata,"a"
.p2align 6
.amdhsa_kernel ln_kernel
.amdhsa_next_free_vgpr 168
.amdhsa_next_free_sgpr 102
.amdhsa_accum_offset 168
.amdhsa_group_segment_fixed_size 0
.amdhsa_kernarg_size 120
.amdhsa_user_sgpr_count 2
.amdhsa_user_sgpr_kernarg_segment_ptr 1
.amdhsa_system_sgpr_workgroup_id_x 1
.end_amdhsa_kernel
.section .rodata,"a"
.p2align 6
.amdhsa_kernel gemm1_kernel
.amdhsa_next_free_vgpr 240
.amdhsa_next_free_sgpr 102
.amdhsa_accum_offset 240
.amdhsa_group_segment_fixed_size 0
.amdhsa_kernarg_size 120
.amdhsa_user_sgpr_count 2
.amdhsa_user_sgpr_kernarg_segment_ptr 1
.amdhsa_system_sgpr_workgroup_id_x 1
.end_amdhsa_kernel
.section .rodata,"a"
.p2align 6
.amdhsa_kernel gemm2_kernel
.amdhsa_next_free_vgpr 192
.amdhsa_next_free_sgpr 102
.amdhsa_accum_offset 192
.amdhsa_group_segment_fixed_size 0
.amdhsa_kernarg_size 120
.amdhsa_user_sgpr_count 2
.amdhsa_user_sgpr_kernarg_segment_ptr 1
.amdhsa_system_sgpr_workgroup_id_x 1
.end_amdhsa_kernel
```
